```python
import torch

def _softmax(x, axis=-1):
    return torch.softmax(x, dim=axis)

def _gelu(x):
    return torch.nn.functional.gelu(x, approximate='tanh')

def _silu(x):
    return torch.nn.functional.silu(x)

def _sigmoid(x):
    return torch.sigmoid(x)

def _layernorm(x, axis=-1, eps=1e-05):
    m = x.mean(dim=axis, keepdim=True)
    v = x.var(dim=axis, keepdim=True, unbiased=False)
    return (x - m) / torch.sqrt(v + eps)

def _scatter_add(tgt, idx, src, axis=0):
    return tgt.clone().index_add_(axis, idx, src)

def _segment_sum(src, seg, n):
    out = torch.zeros((n,) + src.shape[1:], dtype=src.dtype)
    return out.index_add_(0, seg, src)

def _pad(x, pw):
    flat = tuple((v for pair in reversed(pw) for v in pair))
    return torch.nn.functional.pad(x, flat)
kernel_name = 'gather_scatter__tensor_product_equiv_equiformer__graph'

def setup_inputs():

    _w = lambda a: (lambda t: t.to(torch.bfloat16) if t.is_floating_point() else t)(torch.as_tensor(a))
    N, deg, C, De = (10000, 16, 128, max(16, 1))
    E = N * deg
    src = (lambda lo, hi, *s: torch.randint(lo, hi, s))(0, N, E).to(torch.int64)
    dst = (lambda lo, hi, *s: torch.randint(lo, hi, s))(0, N, E).to(torch.int64)
    rvec = (lambda *s: torch.randn(*s, dtype=torch.bfloat16) * 0.05)(E, 3).to(float)
    rn = (torch.linalg.norm(rvec, dim=-1, keepdim=True) + 1e-06).to(float)
    rhat = (rvec / rn).to(float)
    eps = torch.zeros((3, 3, 3), dtype=float)
    eps[0, 1, 2] = eps[1, 2, 0] = eps[2, 0, 1] = 1.0
    eps[0, 2, 1] = eps[2, 1, 0] = eps[1, 0, 2] = -1.0
    return {'x': _w((lambda *s: torch.randn(*s, dtype=torch.bfloat16) * 0.2)(N, 4 * C).to(float)), 'rhat': _w(rhat), 'e_attr': _w((lambda *s: torch.randn(*s, dtype=torch.bfloat16) * 0.2)(E, De).to(float)), 'src': _w(src), 'dst': _w(dst), 'w_rad': _w((lambda *s: torch.randn(*s, dtype=torch.bfloat16) * 0.2)(De, 5 * C).to(float)), 'w_si0': _w((lambda *s: torch.randn(*s, dtype=torch.bfloat16) * 0.2)(2 * C, C).to(float)), 'w_si1': _w((lambda *s: torch.randn(*s, dtype=torch.bfloat16) * 0.05)(3 * C, C).to(float)), 'cg_eps': _w(eps)}

def reference(x, rhat, e_attr, src, dst, w_rad, w_si0, w_si1, cg_eps):
    N = x.shape[0]
    C = w_si0.shape[1]
    E = rhat.shape[0]
    x0 = x[:, :C].clone()
    x1 = x[:, C:].reshape(N, 3, C)
    R = (e_attr @ w_rad).reshape(E, 5, C)
    f0 = x0[src]
    f1 = x1[src]
    Y1 = rhat
    p00_0 = f0 * R[:, 0, :]
    p11_0 = torch.einsum('ejc,ej->ec', f1, Y1) * R[:, 1, :]
    p01_1 = torch.einsum('ec,ej->ejc', f0, Y1) * R[:, 2, :][:, None, :]
    p10_1 = f1 * R[:, 3, :][:, None, :]
    p11_1 = torch.einsum('ijk,ekc,ej->eic', cg_eps, f1, Y1) * R[:, 4, :][:, None, :]
    m0 = torch.concatenate([p00_0, p11_0], axis=-1) @ w_si0
    m1 = torch.einsum('ejp,pc->ejc', torch.concatenate([p01_1, p10_1, p11_1], axis=-1), w_si1)
    agg0 = _segment_sum(m0, dst, N)
    agg1 = _segment_sum(m1.reshape(E, 3 * C), dst, N).reshape(N, 3, C)
    gate = _sigmoid(agg0)
    out1 = agg1 * gate[:, None, :]
    return torch.concatenate([agg0, out1.reshape(N, 3 * C)], axis=-1)
```

```asm
; @launch kernel=bin_kernel grid=(176,1,1) block=(1024,1,1) lds=33792
; @launch kernel=gather_scatter__tensor_product_equiv_equiformer__graph_kernel grid=(256,1,1) block=(512,1,1) lds=162176
.amdgcn_target "amdgcn-amd-amdhsa--gfx950"
.text
.globl bin_kernel
.p2align 8
.type bin_kernel,@function
bin_kernel:
    s_load_dwordx4 s[4:7], s[0:1], 24
    s_load_dwordx2 s[20:21], s[0:1], 88

    s_cmp_ge_u32 s2, 64
    s_cbranch_scc1 K1_other
    s_waitcnt lgkmcnt(0)
    s_mov_b32 s8, s4
    s_and_b32 s9, s5, 0xffff
    s_mov_b32 s10, 640000
    s_mov_b32 s11, 0x00020000
    s_mov_b32 s12, s6
    s_and_b32 s13, s7, 0xffff
    s_mov_b32 s14, 640000
    s_mov_b32 s15, 0x00020000
    s_mov_b32 s16, s20
    s_and_b32 s17, s21, 0xffff
    s_mov_b32 s18, 2097152
    s_mov_b32 s19, 0x00020000
    s_mul_i32 s3, s2, 10000
    v_lshlrev_b32 v1, 2, v0
    s_add_u32 s22, s3, 0
    buffer_load_dword v10, v1, s[12:15], s22 offen
    buffer_load_dword v14, v1, s[8:11], s22 offen
    s_add_u32 s22, s3, 4096
    buffer_load_dword v11, v1, s[12:15], s22 offen
    buffer_load_dword v15, v1, s[8:11], s22 offen
    s_add_u32 s22, s3, 8192
    buffer_load_dword v12, v1, s[12:15], s22 offen
    buffer_load_dword v16, v1, s[8:11], s22 offen
    v_mov_b32 v4, -1
    v_mov_b32 v5, -1
    v_mov_b32 v6, -1
    v_mov_b32 v7, -1
    v_lshlrev_b32 v2, 4, v0
    ds_write_b128 v2, v[4:7]

    ds_write_b128 v2, v[4:7] offset:16384
    v_mov_b32 v3, 0
    v_cmp_gt_u32 vcc, 256, v0
    s_and_saveexec_b64 s[24:25], vcc
    ds_write_b32 v1, v3 offset:32768
    s_mov_b64 exec, s[24:25]
    s_mov_b32 s23, 429497
    v_mov_b32 v9, 1
    s_waitcnt lgkmcnt(0)
    s_barrier
    s_waitcnt vmcnt(4)
    v_mul_u32_u24 v18, s23, v10
    v_lshrrev_b32 v18, 24, v18
    v_lshlrev_b32 v3, 2, v18
    ds_add_rtn_u32 v22, v3, v9 offset:32768
    v_mul_u32_u24 v3, 625, v18
    v_add_u32 v3, 15, v3
    v_lshrrev_b32 v3, 4, v3
    v_sub_u32 v3, v10, v3
    v_and_b32 v14, 0x3fff, v14
    v_lshl_or_b32 v14, v3, 14, v14
    v_add_u32 v3, 0, v0
    v_lshl_or_b32 v14, v3, 20, v14
    s_waitcnt vmcnt(2)
    v_mul_u32_u24 v19, s23, v11
    v_lshrrev_b32 v19, 24, v19
    v_lshlrev_b32 v3, 2, v19
    ds_add_rtn_u32 v23, v3, v9 offset:32768
    v_mul_u32_u24 v3, 625, v19
    v_add_u32 v3, 15, v3
    v_lshrrev_b32 v3, 4, v3
    v_sub_u32 v3, v11, v3
    v_and_b32 v15, 0x3fff, v15
    v_lshl_or_b32 v15, v3, 14, v15
    v_add_u32 v3, 1024, v0
    v_lshl_or_b32 v15, v3, 20, v15
    s_waitcnt vmcnt(0)
    v_cmp_gt_u32 vcc, 452, v0
    s_and_saveexec_b64 s[24:25], vcc
    v_mul_u32_u24 v20, s23, v12
    v_lshrrev_b32 v20, 24, v20
    v_lshlrev_b32 v3, 2, v20
    ds_add_rtn_u32 v24, v3, v9 offset:32768
    v_mul_u32_u24 v3, 625, v20
    v_add_u32 v3, 15, v3
    v_lshrrev_b32 v3, 4, v3
    v_sub_u32 v3, v12, v3
    v_and_b32 v16, 0x3fff, v16
    v_lshl_or_b32 v16, v3, 14, v16
    v_add_u32 v3, 2048, v0
    v_lshl_or_b32 v16, v3, 20, v16
    s_waitcnt lgkmcnt(0)
    v_cmp_gt_u32 vcc, 32, v24
    s_and_b64 exec, exec, vcc
    v_and_b32 v3, 7, v24
    v_lshrrev_b32 v24, 3, v24
    v_lshl_add_u32 v3, v3, 2, v24
    v_and_b32 v8, 255, v20
    v_lshl_add_u32 v3, v8, 5, v3
    v_lshlrev_b32 v3, 2, v3
    ds_write_b32 v3, v16
    s_mov_b64 exec, -1
    s_waitcnt lgkmcnt(0)
    v_cmp_gt_u32 vcc, 32, v23
    s_and_b64 exec, exec, vcc
    v_and_b32 v3, 7, v23
    v_lshrrev_b32 v23, 3, v23
    v_lshl_add_u32 v3, v3, 2, v23
    v_and_b32 v8, 255, v19
    v_lshl_add_u32 v3, v8, 5, v3
    v_lshlrev_b32 v3, 2, v3
    ds_write_b32 v3, v15
    s_mov_b64 exec, -1
    s_waitcnt lgkmcnt(0)
    v_cmp_gt_u32 vcc, 32, v22
    s_and_b64 exec, exec, vcc
    v_and_b32 v3, 7, v22
    v_lshrrev_b32 v22, 3, v22
    v_lshl_add_u32 v3, v3, 2, v22
    v_and_b32 v8, 255, v18
    v_lshl_add_u32 v3, v8, 5, v3
    v_lshlrev_b32 v3, 2, v3
    ds_write_b32 v3, v14
    s_mov_b64 exec, -1
    s_waitcnt lgkmcnt(0)
    s_barrier
    v_lshrrev_b32 v3, 3, v0
    v_lshlrev_b32 v8, 2, v3
    ds_read_b128 v[12:15], v2
    ds_read_b32 v10, v8 offset:32768
    ds_read_b128 v[16:19], v2 offset:16384
    ds_read_b32 v11, v8 offset:33280
    v_and_b32 v20, 7, v0
    v_lshlrev_b32 v20, 4, v20
    v_lshl_add_u32 v20, v3, 13, v20
    s_lshl_b32 s22, s2, 7
    v_mov_b32 v21, -2
    s_waitcnt lgkmcnt(2)
    v_cmp_lt_u32 vcc, 32, v10
    s_nop 1
    v_cndmask_b32 v12, v12, v21, vcc
    buffer_store_dwordx4 v[12:15], v20, s[16:19], s22 offen
    s_waitcnt lgkmcnt(0)
    v_cmp_lt_u32 vcc, 32, v11
    s_nop 1
    v_cndmask_b32 v16, v16, v21, vcc
    s_add_u32 s22, s22, 0x100000
    buffer_store_dwordx4 v[16:19], v20, s[16:19], s22 offen
    s_endpgm
K1_other:
    s_load_dwordx4 s[8:11], s[0:1], 40
    s_load_dwordx2 s[12:13], s[0:1], 56
    s_load_dwordx4 s[28:31], s[0:1], 0
    s_load_dwordx2 s[32:33], s[0:1], 16
    s_load_dwordx2 s[34:35], s[0:1], 72
    s_cmp_ge_u32 s2, 76
    s_cbranch_scc1 K1_pref
    s_waitcnt lgkmcnt(0)
    v_lshrrev_b32 v1, 6, v0
    s_nop 0
    v_readfirstlane_b32 s3, v1
    v_and_b32 v1, 63, v0
    s_sub_u32 s14, s2, 64
    s_lshl_b32 s14, s14, 4
    s_add_u32 s3, s3, s14
    s_cmp_ge_u32 s3, 180
    s_cbranch_scc1 K1_end
    s_cmp_ge_u32 s3, 160
    s_cbranch_scc1 K1_wrad
    s_mul_i32 s14, s3, 205
    s_lshr_b32 s14, s14, 13
    s_mul_i32 s15, s14, 40
    s_sub_u32 s15, s3, s15
    v_lshrrev_b32 v2, 5, v1
    v_and_b32 v3, 3, v1
    v_bfe_u32 v4, v1, 3, 2
    v_lshl_add_u32 v3, v4, 2, v3
    v_bfe_u32 v4, v1, 2, 1
    v_lshl_add_u32 v3, v4, 4, v3
    s_lshl_b32 s14, s14, 5
    v_add_u32 v3, s14, v3
    v_lshlrev_b32 v3, 1, v3
    s_cmp_ge_u32 s15, 16
    s_cbranch_scc1 K1_m1
    s_lshl_b32 s16, s15, 3
    s_mov_b32 s17, 1
    s_mov_b32 s24, s10
    s_mov_b32 s25, s11
    s_mov_b32 s26, 65536
    s_branch K1_wld
K1_m1:
    s_sub_u32 s15, s15, 16
    s_cmp_ge_u32 s15, 12
    s_cselect_b32 s18, 1, 0
    s_mul_i32 s19, s18, 12
    s_sub_u32 s15, s15, s19
    s_lshl_b32 s18, s18, 6
    s_lshl_b32 s16, s15, 3
    s_add_u32 s16, s16, s18
    s_mov_b32 s17, 1
    s_mov_b32 s24, s12
    s_mov_b32 s25, s13
    s_mov_b32 s26, 98304
    s_cmp_lt_u32 s15, 8
    s_cbranch_scc1 K1_wld
    s_lshl_b32 s16, s15, 4
    s_add_u32 s16, s16, s18
    s_add_u32 s16, s16, 128
    s_mov_b32 s17, 0
K1_wld:
    s_and_b32 s25, s25, 0xffff
    s_mov_b32 s27, 0x00020000
    s_lshl_b32 s16, s16, 8
    s_cmp_eq_u32 s17, 0
    s_cbranch_scc1 K1_wlin
    v_lshl_add_u32 v3, v2, 10, v3
    s_add_u32 s17, s16, 32768
    buffer_load_ushort v10, v3, s[24:27], s16 offen offset:0
    buffer_load_ushort v11, v3, s[24:27], s17 offen offset:0
    buffer_load_ushort v12, v3, s[24:27], s16 offen offset:256
    buffer_load_ushort v13, v3, s[24:27], s17 offen offset:256
    buffer_load_ushort v14, v3, s[24:27], s16 offen offset:512
    buffer_load_ushort v15, v3, s[24:27], s17 offen offset:512
    buffer_load_ushort v16, v3, s[24:27], s16 offen offset:768
    buffer_load_ushort v17, v3, s[24:27], s17 offen offset:768
    s_branch K1_wst
K1_wlin:
    v_lshl_add_u32 v3, v2, 11, v3
    buffer_load_ushort v10, v3, s[24:27], s16 offen offset:0
    buffer_load_ushort v11, v3, s[24:27], s16 offen offset:256
    buffer_load_ushort v12, v3, s[24:27], s16 offen offset:512
    buffer_load_ushort v13, v3, s[24:27], s16 offen offset:768
    buffer_load_ushort v14, v3, s[24:27], s16 offen offset:1024
    buffer_load_ushort v15, v3, s[24:27], s16 offen offset:1280
    buffer_load_ushort v16, v3, s[24:27], s16 offen offset:1536
    buffer_load_ushort v17, v3, s[24:27], s16 offen offset:1792
K1_wst:
    s_lshl_b32 s3, s3, 10
    s_add_u32 s3, s3, 2097152
    s_branch K1_st
K1_wrad:
    s_sub_u32 s3, s3, 160
    s_cmp_ge_u32 s3, 10
    s_cselect_b32 s14, 1, 0
    s_mul_i32 s15, s14, 10
    s_sub_u32 s15, s3, s15
    s_lshr_b32 s16, s15, 1
    s_lshl_b32 s16, s16, 7
    s_lshl_b32 s14, s14, 6
    s_add_u32 s16, s16, s14
    s_and_b32 s15, s15, 1
    s_mul_i32 s15, s15, 10240
    s_lshl_b32 s16, s16, 1
    s_add_u32 s16, s16, s15
    v_lshrrev_b32 v2, 5, v1
    v_mul_u32_u24 v2, 5120, v2
    v_and_b32 v3, 31, v1
    v_lshl_add_u32 v3, v3, 1, v2
    s_mov_b32 s24, s8
    s_and_b32 s25, s9, 0xffff
    s_mov_b32 s26, 20480
    s_mov_b32 s27, 0x00020000
    buffer_load_ushort v10, v3, s[24:27], s16 offen offset:0
    buffer_load_ushort v11, v3, s[24:27], s16 offen offset:1280
    buffer_load_ushort v12, v3, s[24:27], s16 offen offset:64
    buffer_load_ushort v13, v3, s[24:27], s16 offen offset:1344
    buffer_load_ushort v14, v3, s[24:27], s16 offen offset:2560
    buffer_load_ushort v15, v3, s[24:27], s16 offen offset:3840
    buffer_load_ushort v16, v3, s[24:27], s16 offen offset:2624
    buffer_load_ushort v17, v3, s[24:27], s16 offen offset:3904
    s_lshl_b32 s3, s3, 10
    s_add_u32 s3, s3, 2293760
K1_st:
    s_mov_b32 s24, s20
    s_and_b32 s25, s21, 0xffff
    s_mov_b32 s26, 2314240
    s_mov_b32 s27, 0x00020000
    v_lshlrev_b32 v1, 4, v1
    s_waitcnt vmcnt(0)
    v_lshl_or_b32 v20, v11, 16, v10
    v_lshl_or_b32 v21, v13, 16, v12
    v_lshl_or_b32 v22, v15, 16, v14
    v_lshl_or_b32 v23, v17, 16, v16
    buffer_store_dwordx4 v[20:23], v1, s[24:27], s3 offen
    s_endpgm
K1_pref:
    s_cmp_ge_u32 s2, 176
    s_cbranch_scc1 K1_end
    s_cmp_lt_u32 s2, 80
    s_cbranch_scc1 K1_end
    s_waitcnt lgkmcnt(0)
    s_sub_u32 s3, s2, 80
    s_lshr_b32 s3, s3, 3
    s_lshl_b32 s3, s3, 14
    v_lshlrev_b32 v1, 4, v0
    s_mov_b32 s24, s30
    s_and_b32 s25, s31, 0xffff
    s_mov_b32 s26, 960000
    s_mov_b32 s27, 0x00020000
    s_lshr_b32 s14, s3, 14
    s_mul_i32 s14, s14, 80000
    v_lshlrev_b32 v2, 7, v0
    v_cmp_gt_u32 vcc, 625, v0
    s_nop 1
    v_cndmask_b32 v2, -1, v2, vcc
    buffer_load_dword v4, v2, s[24:27], s14 offen
    s_mov_b32 s16, s28
    s_and_b32 s17, s29, 0xffff
    s_mov_b32 s18, 0
    s_mov_b32 s19, 0x00020000
    s_waitcnt vmcnt(0)
K1_end:
    s_endpgm
.globl gather_scatter__tensor_product_equiv_equiformer__graph_kernel
.p2align 8
.type gather_scatter__tensor_product_equiv_equiformer__graph_kernel,@function
gather_scatter__tensor_product_equiv_equiformer__graph_kernel:
    s_cmp_ge_u32 s2, 256
    s_cbranch_scc1 K2_end
    s_load_dwordx4 s[56:59], s[0:1], 0
    s_load_dwordx2 s[60:61], s[0:1], 16
    s_load_dwordx4 s[24:27], s[0:1], 24
    s_load_dwordx2 s[62:63], s[0:1], 72
    s_load_dwordx2 s[64:65], s[0:1], 88
    s_load_dwordx2 s[90:91], s[0:1], 80
    v_mov_b32 v198, v0
    v_lshrrev_b32 v1, 6, v0
    s_mov_b32 s32, s2
    v_readfirstlane_b32 s33, v1
    v_and_b32 v2, 63, v0
    s_mov_b32 s43, 0
    s_mov_b32 s44, 0
    s_mov_b32 s45, 8
    s_mov_b32 s47, 1
    s_mov_b32 s94, 1
    s_lshr_b32 s34, s33, 1
    s_and_b32 s35, s33, 1
    s_mul_i32 s39, s33, 14848
    s_add_u32 s40, s39, 12288
    s_mov_b32 s41, s40
    s_mul_i32 s92, s2, 625
    s_add_u32 s93, s92, 640
    s_add_u32 s92, s92, 15
    s_lshr_b32 s92, s92, 4
    s_lshr_b32 s93, s93, 4
    s_sub_u32 s93, s93, s92
    s_waitcnt lgkmcnt(0)
    s_mov_b32 s20, s64
    s_and_b32 s21, s65, 0xffff
    s_mov_b32 s22, 2314240
    s_mov_b32 s23, 0x00020000
    s_lshl_b32 s46, s32, 13
    v_lshlrev_b32 v120, 4, v0
    buffer_load_dwordx4 v[124:127], v120, s[20:23], s46 offen
    s_mov_b32 s4, s56
    s_and_b32 s5, s57, 0xffff
    s_or_b32 s5, s5, 0x4000000
    s_mov_b32 s6, 10000
    s_mov_b32 s7, 0x00020000
    s_mov_b32 s8, s60
    s_and_b32 s9, s61, 0xffff
    s_or_b32 s9, s9, 0x200000
    s_mov_b32 s10, 160000
    s_mov_b32 s11, 0x00020000
    s_mov_b32 s12, s58
    s_and_b32 s13, s59, 0xffff
    s_mov_b32 s14, 960000
    s_mov_b32 s15, 0x00020000
    s_mov_b32 s16, s62
    s_and_b32 s17, s63, 0xffff
    s_mov_b32 s18, 10240000
    s_mov_b32 s19, 0x00020000
    v_lshlrev_b32 v3, 4, v2
    s_mul_i32 s3, s35, 10240
    s_add_u32 s3, s3, 2293760
    s_add_u32 s46, s3, 4096
    buffer_load_dwordx4 v[204:207], v3, s[20:23], s46 offen offset:0
    buffer_load_dwordx4 v[208:211], v3, s[20:23], s46 offen offset:1024
    s_add_u32 s46, s3, 6144
    buffer_load_dwordx4 v[212:215], v3, s[20:23], s46 offen offset:0
    buffer_load_dwordx4 v[216:219], v3, s[20:23], s46 offen offset:1024
    s_add_u32 s46, s3, 0
    buffer_load_dwordx4 v[220:223], v3, s[20:23], s46 offen offset:0
    buffer_load_dwordx4 v[224:227], v3, s[20:23], s46 offen offset:1024
    s_cmp_lt_u32 s34, 2
    s_cselect_b32 s67, 8192, 0
    s_lshl_b32 s66, s34, 10
    s_add_u32 s3, s3, s67
    s_add_u32 s3, s3, s66
    s_lshl_b32 s46, s35, 12
    s_add_u32 s46, s46, 142720
    s_add_u32 m0, s46, s66
    v_add_u32 v111, s46, v3
    buffer_load_dwordx4 v3, s[20:23], s3 offen lds
    v_bfe_u32 v6, v2, 3, 2
    v_add_u32 v4, 1, v6
    v_and_b32 v4, 3, v4
    v_lshlrev_b32 v4, 8, v4
    v_lshrrev_b32 v6, 1, v6
    v_lshlrev_b32 v6, 2, v6
    v_and_b32 v5, 7, v2
    v_xor_b32 v5, v5, v6
    v_lshl_add_u32 v4, v5, 4, v4
    s_lshl_b32 s46, s35, 7
    v_add_u32 v253, s46, v4
    v_and_b32 v4, 1, v2
    v_lshlrev_b32 v255, 4, v4
    s_branch K2_init
K2_batch:
    v_mbcnt_lo_u32_b32 v198, -1, 0
    v_mbcnt_hi_u32_b32 v198, -1, v198
    s_lshl_b32 s46, s33, 6
    v_add_u32 v198, s46, v198
    s_barrier
    v_lshlrev_b32 v120, 4, v198
    s_cmp_lg_u32 s43, 0
    s_cbranch_scc1 K2_scanld
    s_lshl_b32 s46, s32, 13
    buffer_load_dwordx4 v[124:127], v120, s[20:23], s46 offen
    s_branch K2_init
K2_scanld:
    s_mov_b32 s28, s26
    s_and_b32 s29, s27, 0xffff
    s_mov_b32 s30, 640000
    s_mov_b32 s31, 0x00020000
    s_lshl_b32 s46, s44, 13
    buffer_load_dwordx4 v[128:131], v120, s[28:31], s46 offen
    s_mov_b32 s56, s24
    s_and_b32 s57, s25, 0xffff
    s_mov_b32 s58, 640000
    s_mov_b32 s59, 0x00020000
    buffer_load_dwordx4 v[132:135], v120, s[56:59], s46 offen
K2_init:
    v_add_u32 v140, 0, v198
    v_mul_u32_u24 v141, 2979, v140
    v_lshrrev_b32 v141, 16, v141
    v_mul_u32_u24 v141, 22, v141
    v_sub_u32 v141, v140, v141
    v_cmp_gt_u32 vcc, 20, v141
    v_lshrrev_b32 v141, 2, v141
    v_cmp_eq_u32 s[66:67], 4, v141
    v_cndmask_b32 v147, 0, -1, vcc
    v_lshlrev_b32 v141, 4, v140
    v_cndmask_b32 v144, 0, -1, s[66:67]
    v_add_u32 v141, 118784, v141
    v_mov_b32 v145, v144
    v_mov_b32 v146, v144
    ds_write_b128 v141, v[144:147]
    v_add_u32 v140, 512, v198
    v_mul_u32_u24 v141, 2979, v140
    v_lshrrev_b32 v141, 16, v141
    v_mul_u32_u24 v141, 22, v141
    v_sub_u32 v141, v140, v141
    v_cmp_gt_u32 vcc, 20, v141
    v_lshrrev_b32 v141, 2, v141
    v_cmp_eq_u32 s[66:67], 4, v141
    v_cndmask_b32 v147, 0, -1, vcc
    v_lshlrev_b32 v141, 4, v140
    v_cndmask_b32 v144, 0, -1, s[66:67]
    v_add_u32 v141, 118784, v141
    v_mov_b32 v145, v144
    v_mov_b32 v146, v144
    ds_write_b128 v141, v[144:147]
    v_add_u32 v140, 1024, v198
    v_mul_u32_u24 v141, 2979, v140
    v_lshrrev_b32 v141, 16, v141
    v_mul_u32_u24 v141, 22, v141
    v_sub_u32 v141, v140, v141
    v_cmp_gt_u32 vcc, 20, v141
    v_lshrrev_b32 v141, 2, v141
    v_cmp_eq_u32 s[66:67], 4, v141
    v_cndmask_b32 v147, 0, -1, vcc
    v_lshlrev_b32 v141, 4, v140
    v_cndmask_b32 v144, 0, -1, s[66:67]
    v_add_u32 v141, 118784, v141
    v_mov_b32 v145, v144
    v_mov_b32 v146, v144
    v_cmp_gt_u32 vcc, 1496, v140
    s_and_b64 exec, exec, vcc
    ds_write_b128 v141, v[144:147]
    s_mov_b64 exec, -1
    v_cmp_gt_u32 vcc, 128, v198
    s_and_b64 exec, exec, vcc
    v_lshlrev_b32 v140, 2, v198
    v_add_u32 v140, 150912, v140
    v_mov_b32 v141, 0
    ds_write_b32 v140, v141
    s_mov_b64 exec, -1
    s_mul_i32 s46, s34, 5632
    s_add_u32 s46, s46, 118784
    v_and_b32 v140, 63, v198
    v_lshrrev_b32 v141, 2, v140
    v_lshl_add_u32 v103, v141, 4, s46
    v_lshrrev_b32 v141, 5, v140
    v_lshl_add_u32 v105, v141, 4, s46
    v_bfe_u32 v142, v140, 1, 4
    v_lshl_add_u32 v142, v142, 2, s46
    v_lshl_add_u32 v109, v141, 18, v142
    v_lshrrev_b32 v141, 4, v140
    v_lshlrev_b32 v141, 2, v141
    v_and_b32 v142, 3, v140
    v_or_b32 v141, v141, v142
    v_and_b32 v142, 8, v140
    v_xor_b32 v141, v141, v142
    v_bfe_u32 v142, v140, 2, 2
    v_lshl_add_u32 v141, v142, 4, v141
    v_lshl_add_u32 v101, v141, 3, s39
    s_waitcnt lgkmcnt(0)
    s_barrier
    s_cmp_lg_u32 s43, 0
    s_cbranch_scc1 K2_scandec
    s_cmp_lg_u32 s47, 0
    s_cbranch_scc1 K2_w7
    s_waitcnt vmcnt(0)
K2_w7:
    s_waitcnt vmcnt(7)
    v_lshrrev_b32 v140, 3, v198
    v_mul_u32_u24 v140, 2500, v140
    v_cmp_eq_u32 vcc, -2, v124
    s_and_saveexec_b64 s[66:67], vcc
    v_mov_b32 v141, 151168
    ds_write_b32 v141, v141
    s_mov_b64 exec, s[66:67]
    v_bfe_u32 v128, v124, 14, 6
    v_and_b32 v132, 0x3fff, v124
    v_lshrrev_b32 v136, 20, v124
    v_add_u32 v136, v140, v136
    v_bfe_u32 v129, v125, 14, 6
    v_and_b32 v133, 0x3fff, v125
    v_lshrrev_b32 v137, 20, v125
    v_add_u32 v137, v140, v137
    v_bfe_u32 v130, v126, 14, 6
    v_and_b32 v134, 0x3fff, v126
    v_lshrrev_b32 v138, 20, v126
    v_add_u32 v138, v140, v138
    v_bfe_u32 v131, v127, 14, 6
    v_and_b32 v135, 0x3fff, v127
    v_lshrrev_b32 v139, 20, v127
    v_add_u32 v139, v140, v139
    s_branch K2_common
K2_scandec:
    s_waitcnt vmcnt(0)
    s_lshl_b32 s3, s44, 11
    v_lshl_add_u32 v140, v198, 2, s3
    v_cmp_gt_u32 vcc, 160000, v140
    v_subrev_u32 v128, s92, v128
    v_and_b32 v132, 0x3fff, v132
    v_add_u32 v136, 0, v140
    v_cndmask_b32 v128, 63, v128, vcc
    v_subrev_u32 v129, s92, v129
    v_and_b32 v133, 0x3fff, v133
    v_add_u32 v137, 1, v140
    v_cndmask_b32 v129, 63, v129, vcc
    v_subrev_u32 v130, s92, v130
    v_and_b32 v134, 0x3fff, v134
    v_add_u32 v138, 2, v140
    v_cndmask_b32 v130, 63, v130, vcc
    v_subrev_u32 v131, s92, v131
    v_and_b32 v135, 0x3fff, v135
    v_add_u32 v139, 3, v140
    v_cndmask_b32 v131, 63, v131, vcc
K2_common:
    s_cmp_eq_u32 s45, 8
    s_cselect_b32 s46, s93, 0
    s_cmp_eq_u32 s45, s33
    s_cselect_b32 s46, s93, s46
    v_mov_b32 v141, 1
    s_mov_b32 s66, 151232
    v_cmp_gt_u32 s[70:71], s46, v128
    s_mov_b64 exec, s[70:71]
    s_cbranch_execz K2_sa0
    v_lshl_add_u32 v128, v128, 2, s66
    v_mul_u32_u24 v140, 6, v136
    ds_add_u32 v128, v141
    v_and_b32 v140, -4, v140
    buffer_load_dwordx2 v[160:161], v140, s[12:15], 0 offen
K2_sa0:
    s_mov_b64 exec, -1
    v_cmp_gt_u32 s[72:73], s46, v129
    s_mov_b64 exec, s[72:73]
    s_cbranch_execz K2_sa1
    v_lshl_add_u32 v129, v129, 2, s66
    v_mul_u32_u24 v140, 6, v137
    ds_add_u32 v129, v141
    v_and_b32 v140, -4, v140
    buffer_load_dwordx2 v[162:163], v140, s[12:15], 0 offen
K2_sa1:
    s_mov_b64 exec, -1
    v_cmp_gt_u32 s[74:75], s46, v130
    s_mov_b64 exec, s[74:75]
    s_cbranch_execz K2_sa2
    v_lshl_add_u32 v130, v130, 2, s66
    v_mul_u32_u24 v140, 6, v138
    ds_add_u32 v130, v141
    v_and_b32 v140, -4, v140
    buffer_load_dwordx2 v[164:165], v140, s[12:15], 0 offen
K2_sa2:
    s_mov_b64 exec, -1
    v_cmp_gt_u32 s[76:77], s46, v131
    s_mov_b64 exec, s[76:77]
    s_cbranch_execz K2_sa3
    v_lshl_add_u32 v131, v131, 2, s66
    v_mul_u32_u24 v140, 6, v139
    ds_add_u32 v131, v141
    v_and_b32 v140, -4, v140
    buffer_load_dwordx2 v[166:167], v140, s[12:15], 0 offen
K2_sa3:
    s_mov_b64 exec, -1
    s_cmp_lg_u32 s47, 0
    s_cbranch_scc1 K2_asg
    s_waitcnt vmcnt(0)
    s_branch K2_asgd
K2_asg:
    v_lshrrev_b32 v142, 3, v198
    v_and_b32 v143, 7, v198
    v_mul_u32_u24 v143, 5, v143
    v_lshl_add_u32 v144, v142, 2, s66
    v_lshl_add_u32 v145, v143, 2, s66
    s_waitcnt lgkmcnt(0)
    s_barrier
    s_cmp_ge_u32 s33, 5
    s_cbranch_scc1 K2_asgw
    ds_read_b32 v146, v144
    ds_read2_b32 v[148:149], v145 offset1:1
    ds_read2_b32 v[150:151], v145 offset0:2 offset1:3
    ds_read_b32 v152, v145 offset:16
    v_sub_u32 v143, v142, v143
    v_mov_b32 v147, 0
    s_waitcnt lgkmcnt(0)
    v_lshl_add_u32 v146, v146, 6, v143
    v_lshl_add_u32 v148, v148, 6, 0
    v_lshl_add_u32 v149, v149, 6, 1
    v_lshl_add_u32 v150, v150, 6, 2
    v_lshl_add_u32 v151, v151, 6, 3
    v_lshl_add_u32 v152, v152, 6, 4
    v_cmp_gt_i32 vcc, v148, v146
    s_nop 1
    v_addc_co_u32 v147, vcc, 0, v147, vcc
    v_cmp_gt_i32 vcc, v149, v146
    s_nop 1
    v_addc_co_u32 v147, vcc, 0, v147, vcc
    v_cmp_gt_i32 vcc, v150, v146
    s_nop 1
    v_addc_co_u32 v147, vcc, 0, v147, vcc
    v_cmp_gt_i32 vcc, v151, v146
    s_nop 1
    v_addc_co_u32 v147, vcc, 0, v147, vcc
    v_cmp_gt_i32 vcc, v152, v146
    s_nop 1
    v_addc_co_u32 v147, vcc, 0, v147, vcc
    s_nop 1
    v_add_u32_dpp v147, v147, v147 quad_perm:[1,0,3,2] row_mask:0xf bank_mask:0xf
    s_nop 1
    v_add_u32_dpp v147, v147, v147 quad_perm:[2,3,0,1] row_mask:0xf bank_mask:0xf
    s_nop 1
    v_add_u32_dpp v147, v147, v147 row_half_mirror row_mask:0xf bank_mask:0xf
    s_nop 1
    v_bfe_i32 v146, v147, 2, 1
    v_and_b32 v146, 3, v146
    v_xor_b32 v147, v147, v146
    v_lshl_add_u32 v146, v147, 2, s66
    ds_write_b32 v144, v147 offset:192
    ds_write_b32 v146, v142 offset:448
K2_asgw:
    s_lshr_b32 s67, s32, 3
    s_mul_i32 s67, s67, 3
    s_add_u32 s67, s67, s33
    s_add_u32 s67, s67, -5
    s_lshl_b32 s67, s67, 3
    s_cmp_ge_u32 s33, 5
    s_cselect_b32 s67, s67, 0x100000
    v_bfe_u32 v168, v198, 3, 3
    v_add_u32 v168, s67, v168
    v_and_b32 v169, 7, v198
    v_lshlrev_b32 v169, 7, v169
    buffer_load_dword v248, v[168:169], s[4:7], 0 idxen offen
    v_add_u32 v168, 768, v168
    s_waitcnt lgkmcnt(0)
    s_barrier
K2_asgd:
    s_mov_b64 exec, s[70:71]
    ds_read_b32 v128, v128 offset:192
    s_mov_b64 exec, s[72:73]
    ds_read_b32 v129, v129 offset:192
    s_mov_b64 exec, s[74:75]
    ds_read_b32 v130, v130 offset:192
    s_mov_b64 exec, s[76:77]
    ds_read_b32 v131, v131 offset:192
    s_mov_b32 s67, 150912
    s_waitcnt lgkmcnt(0)
    s_mov_b64 exec, s[70:71]
    s_cbranch_execz K2_sd0
    v_mul_u32_u24 v142, 85, v132
    v_lshrrev_b32 v142, 16, v142
    v_and_b32 v148, 3, v128
    v_lshl_add_u32 v148, v148, 4, v142
    v_lshlrev_b32 v148, 2, v148
    v_add_u32 v142, s67, v148
    ds_add_rtn_u32 v152, v142, v141
K2_sd0:
    s_mov_b64 exec, s[72:73]
    s_cbranch_execz K2_sd1
    v_mul_u32_u24 v142, 85, v133
    v_lshrrev_b32 v142, 16, v142
    v_and_b32 v149, 3, v129
    v_lshl_add_u32 v149, v149, 4, v142
    v_lshlrev_b32 v149, 2, v149
    v_add_u32 v142, s67, v149
    ds_add_rtn_u32 v153, v142, v141
K2_sd1:
    s_mov_b64 exec, s[74:75]
    s_cbranch_execz K2_sd2
    v_mul_u32_u24 v142, 85, v134
    v_lshrrev_b32 v142, 16, v142
    v_and_b32 v150, 3, v130
    v_lshl_add_u32 v150, v150, 4, v142
    v_lshlrev_b32 v150, 2, v150
    v_add_u32 v142, s67, v150
    ds_add_rtn_u32 v154, v142, v141
K2_sd2:
    s_mov_b64 exec, s[76:77]
    s_cbranch_execz K2_sd3
    v_mul_u32_u24 v142, 85, v135
    v_lshrrev_b32 v142, 16, v142
    v_and_b32 v151, 3, v131
    v_lshl_add_u32 v151, v151, 4, v142
    v_lshlrev_b32 v151, 2, v151
    v_add_u32 v142, s67, v151
    ds_add_rtn_u32 v155, v142, v141
K2_sd3:
    s_mov_b64 exec, -1
    s_waitcnt lgkmcnt(0)
    s_barrier
    v_and_b32 v140, 63, v198
    v_lshlrev_b32 v140, 2, v140
    v_add_u32 v140, 150912, v140
    v_mov_b32 v143, 151168
    ds_read_b32 v141, v140
    ds_read_b32 v143, v143
    s_waitcnt lgkmcnt(1)
    v_mov_b32 v142, v141
    s_nop 1
    v_add_u32_dpp v142, v142, v142 row_shr:1 row_mask:0xf bank_mask:0xf bound_ctrl:1
    s_nop 1
    v_add_u32_dpp v142, v142, v142 row_shr:2 row_mask:0xf bank_mask:0xf bound_ctrl:1
    s_nop 1
    v_add_u32_dpp v142, v142, v142 row_shr:4 row_mask:0xf bank_mask:0xf bound_ctrl:1
    s_nop 1
    v_add_u32_dpp v142, v142, v142 row_shr:8 row_mask:0xf bank_mask:0xf bound_ctrl:1
    s_nop 1
    v_sub_u32 v141, v142, v141
    s_waitcnt lgkmcnt(0)
    v_readfirstlane_b32 s3, v143
    v_readlane_b32 s66, v142, 15
    v_readlane_b32 s67, v142, 31
    v_readlane_b32 s68, v142, 47
    v_readlane_b32 s69, v142, 63
    s_lshl_b32 s46, s34, 4
    s_add_u32 s46, s46, 15
    v_readlane_b32 s36, v142, s46
    ds_bpermute_b32 v156, v148, v141
    ds_bpermute_b32 v157, v149, v141
    ds_bpermute_b32 v158, v150, v141
    ds_bpermute_b32 v159, v151, v141
    s_mov_b32 s47, 0
    s_cmp_lg_u32 s3, 0
    s_cbranch_scc1 K2_toscan
    s_max_u32 s66, s66, s67
    s_max_u32 s68, s68, s69
    s_max_u32 s66, s66, s68
    s_cmp_gt_u32 s66, 256
    s_cbranch_scc1 K2_tosub
    s_mov_b32 s66, 0xc000
    s_mov_b32 s67, 0xffff
    s_waitcnt vmcnt(1) lgkmcnt(0)
    s_mov_b64 exec, s[70:71]
    s_cbranch_execz K2_sb0
    v_add_u32 v140, v152, v156
    v_and_b32 v143, 3, v128
    v_lshrrev_b32 v141, 4, v140
    v_lshl_add_u32 v141, v143, 4, v141
    v_mul_u32_u24 v141, 352, v141
    v_add_u32 v141, 118784, v141
    v_and_b32 v140, 15, v140
    v_lshl_add_u32 v152, v140, 4, v141
    v_lshl_add_u32 v142, v140, 2, v141
    v_lshl_add_u32 v141, v140, 1, v141
    v_lshrrev_b32 v143, 2, v128
    v_lshl_or_b32 v143, v143, 1, s66
    ds_write_b32 v142, v136 offset:256
    ds_write_b16 v141, v143 offset:320
    v_and_b32 v140, 1, v136
    v_lshlrev_b32 v140, 4, v140
    v_lshrrev_b64 v[144:145], v140, v[160:161]
    v_mov_b32 v147, v132
    v_alignbit_b32 v146, v145, v144, 16
    v_and_b32 v145, s67, v145
    v_or_b32 v145, 1.0, v145
    v_xor_b32 v146, 0x80008000, v146
    ds_write_b128 v152, v[144:147]
K2_sb0:
    s_mov_b64 exec, s[72:73]
    s_cbranch_execz K2_sb1
    v_add_u32 v140, v153, v157
    v_and_b32 v143, 3, v129
    v_lshrrev_b32 v141, 4, v140
    v_lshl_add_u32 v141, v143, 4, v141
    v_mul_u32_u24 v141, 352, v141
    v_add_u32 v141, 118784, v141
    v_and_b32 v140, 15, v140
    v_lshl_add_u32 v153, v140, 4, v141
    v_lshl_add_u32 v142, v140, 2, v141
    v_lshl_add_u32 v141, v140, 1, v141
    v_lshrrev_b32 v143, 2, v129
    v_lshl_or_b32 v143, v143, 1, s66
    ds_write_b32 v142, v137 offset:256
    ds_write_b16 v141, v143 offset:320
    v_and_b32 v140, 1, v137
    v_lshlrev_b32 v140, 4, v140
    v_lshrrev_b64 v[144:145], v140, v[162:163]
    v_mov_b32 v147, v133
    v_alignbit_b32 v146, v145, v144, 16
    v_and_b32 v145, s67, v145
    v_or_b32 v145, 1.0, v145
    v_xor_b32 v146, 0x80008000, v146
    ds_write_b128 v153, v[144:147]
K2_sb1:
    s_mov_b64 exec, s[74:75]
    s_cbranch_execz K2_sb2
    v_add_u32 v140, v154, v158
    v_and_b32 v143, 3, v130
    v_lshrrev_b32 v141, 4, v140
    v_lshl_add_u32 v141, v143, 4, v141
    v_mul_u32_u24 v141, 352, v141
    v_add_u32 v141, 118784, v141
    v_and_b32 v140, 15, v140
    v_lshl_add_u32 v154, v140, 4, v141
    v_lshl_add_u32 v142, v140, 2, v141
    v_lshl_add_u32 v141, v140, 1, v141
    v_lshrrev_b32 v143, 2, v130
    v_lshl_or_b32 v143, v143, 1, s66
    ds_write_b32 v142, v138 offset:256
    ds_write_b16 v141, v143 offset:320
    v_and_b32 v140, 1, v138
    v_lshlrev_b32 v140, 4, v140
    v_lshrrev_b64 v[144:145], v140, v[164:165]
    v_mov_b32 v147, v134
    v_alignbit_b32 v146, v145, v144, 16
    v_and_b32 v145, s67, v145
    v_or_b32 v145, 1.0, v145
    v_xor_b32 v146, 0x80008000, v146
    ds_write_b128 v154, v[144:147]
K2_sb2:
    s_mov_b64 exec, s[76:77]
    s_cbranch_execz K2_sb3
    v_add_u32 v140, v155, v159
    v_and_b32 v143, 3, v131
    v_lshrrev_b32 v141, 4, v140
    v_lshl_add_u32 v141, v143, 4, v141
    v_mul_u32_u24 v141, 352, v141
    v_add_u32 v141, 118784, v141
    v_and_b32 v140, 15, v140
    v_lshl_add_u32 v155, v140, 4, v141
    v_lshl_add_u32 v142, v140, 2, v141
    v_lshl_add_u32 v141, v140, 1, v141
    v_lshrrev_b32 v143, 2, v131
    v_lshl_or_b32 v143, v143, 1, s66
    ds_write_b32 v142, v139 offset:256
    ds_write_b16 v141, v143 offset:320
    v_and_b32 v140, 1, v139
    v_lshlrev_b32 v140, 4, v140
    v_lshrrev_b64 v[144:145], v140, v[166:167]
    v_mov_b32 v147, v135
    v_alignbit_b32 v146, v145, v144, 16
    v_and_b32 v145, s67, v145
    v_or_b32 v145, 1.0, v145
    v_xor_b32 v146, 0x80008000, v146
    ds_write_b128 v155, v[144:147]
K2_sb3:
    s_mov_b64 exec, -1
    s_waitcnt lgkmcnt(0)
    s_barrier
    ds_read_b32 v168, v109 offset:256
    ds_read_b32 v169, v109 offset:608
    ds_read_b32 v172, v105 offset:12
    ds_read_b32 v173, v105 offset:44
    ds_read_b32 v174, v105 offset:76
    ds_read_b32 v175, v105 offset:108
    s_waitcnt lgkmcnt(0)
    s_add_u32 m0, s41, 0
    v_mov_b32 v254, v168
    buffer_load_dwordx4 v[254:255], s[8:11], 0 idxen offen lds
    s_add_u32 m0, s39, 0
    v_mov_b32 v252, v172
    buffer_load_dwordx4 v[252:253], s[4:7], 0 idxen offen lds
    s_add_u32 m0, s41, 512
    v_mov_b32 v254, v169
    buffer_load_dwordx4 v[254:255], s[8:11], 0 idxen offen lds
    s_add_u32 m0, s39, 1024
    v_mov_b32 v252, v173
    buffer_load_dwordx4 v[252:253], s[4:7], 0 idxen offen lds
    s_add_u32 m0, s39, 2048
    v_mov_b32 v252, v174
    buffer_load_dwordx4 v[252:253], s[4:7], 0 idxen offen lds
    s_add_u32 m0, s39, 3072
    v_mov_b32 v252, v175
    buffer_load_dwordx4 v[252:253], s[4:7], 0 idxen offen lds
    s_cmp_eq_u32 s94, 0
    s_cbranch_scc1 K2_once
    s_mov_b32 s94, 0
    v_and_b32 v7, 3, v2
    v_bfe_u32 v5, v2, 3, 2
    v_lshl_add_u32 v4, v5, 2, v7
    v_lshlrev_b32 v4, 5, v4
    v_lshrrev_b32 v5, 5, v2
    v_lshl_add_u32 v4, v5, 4, v4
    v_bfe_i32 v6, v2, 2, 1
    v_and_b32 v6, 0xaaaa0000, v6
    v_or_b32 v119, 0x44440000, v6
    v_add_u32 v107, s41, v4
    v_cmp_eq_u32 s[66:67], 1, v7
    v_cmp_eq_u32 s[68:69], 2, v7
    v_cmp_eq_u32 s[70:71], 3, v7
    v_mov_b32 v113, 0x7060c0c
    v_mov_b32 v4, 0xc0c0706
    v_cndmask_b32 v113, v113, v4, s[66:67]
    v_mov_b32 v4, 0x3020100
    v_cndmask_b32 v113, v113, v4, s[68:69]
    v_mov_b32 v4, 0x1000504
    v_cndmask_b32 v113, v113, v4, s[70:71]
    v_mov_b32 v115, 0xc0c0302
    v_mov_b32 v4, 0xc0c0100
    v_cndmask_b32 v115, v115, v4, s[66:67]
    v_mov_b32 v4, 0xc0c0504
    v_cndmask_b32 v115, v115, v4, s[68:69]
    v_mov_b32 v4, 0xc0c0c0c
    v_cndmask_b32 v115, v115, v4, s[70:71]
    v_mov_b32 v117, 0x1000c0c
    v_mov_b32 v4, 0x3020c0c
    v_cndmask_b32 v117, v117, v4, s[66:67]
    v_mov_b32 v4, 0x5040c0c
    v_cndmask_b32 v117, v117, v4, s[68:69]
    v_mov_b32 v4, 0x7060c0c
    v_cndmask_b32 v117, v117, v4, s[70:71]
    v_mov_b32 v244, 0x3f80
    v_mov_b32 v4, 0x3f800000
    v_cndmask_b32 v244, v244, v4, s[66:67]
    v_mov_b32 v4, 0x0
    v_cndmask_b32 v244, v244, v4, s[68:69]
    v_mov_b32 v4, 0x0
    v_cndmask_b32 v244, v244, v4, s[70:71]
    v_mov_b32 v245, 0x0
    v_mov_b32 v4, 0x3f80
    v_cndmask_b32 v245, v245, v4, s[68:69]
    v_mov_b32 v242, 0
    v_mov_b64 v[0:1], 0
    v_mov_b64 v[2:3], 0
    v_mov_b64 v[4:5], 0
    v_mov_b64 v[6:7], 0
    v_mov_b64 v[8:9], 0
    v_mov_b64 v[10:11], 0
    v_mov_b64 v[12:13], 0
    v_mov_b64 v[14:15], 0
    v_mov_b64 v[16:17], 0
    v_mov_b64 v[18:19], 0
    v_mov_b64 v[20:21], 0
    v_mov_b64 v[22:23], 0
    v_mov_b64 v[24:25], 0
    v_mov_b64 v[26:27], 0
    v_mov_b64 v[28:29], 0
    v_mov_b64 v[30:31], 0
    v_mov_b64 v[32:33], 0
    v_mov_b64 v[34:35], 0
    v_mov_b64 v[36:37], 0
    v_mov_b64 v[38:39], 0
    v_mov_b64 v[40:41], 0
    v_mov_b64 v[42:43], 0
    v_mov_b64 v[44:45], 0
    v_mov_b64 v[46:47], 0
    v_mov_b64 v[48:49], 0
    v_mov_b64 v[50:51], 0
    v_mov_b64 v[52:53], 0
    v_mov_b64 v[54:55], 0
    v_mov_b64 v[56:57], 0
    v_mov_b64 v[58:59], 0
    v_mov_b64 v[60:61], 0
    v_mov_b64 v[62:63], 0
    v_mov_b64 v[64:65], 0
    v_mov_b64 v[66:67], 0
    v_mov_b64 v[68:69], 0
    v_mov_b64 v[70:71], 0
    v_mov_b64 v[72:73], 0
    v_mov_b64 v[74:75], 0
    v_mov_b64 v[76:77], 0
    v_mov_b64 v[78:79], 0
    v_mov_b64 v[80:81], 0
    v_mov_b64 v[82:83], 0
    v_mov_b64 v[84:85], 0
    v_mov_b64 v[86:87], 0
    v_mov_b64 v[88:89], 0
    v_mov_b64 v[90:91], 0
    v_mov_b64 v[92:93], 0
    v_mov_b64 v[94:95], 0
    v_mov_b64 v[96:97], 0
    v_mov_b64 v[98:99], 0
    v_mov_b32 v100, 0
    v_mov_b32 v102, 0
    v_mov_b32 v104, 0
    v_mov_b32 v106, 0
    v_mov_b32 v108, 0
    v_mov_b32 v110, 0
    v_mov_b32 v112, 0
    v_mov_b32 v114, 0
    v_mov_b32 v116, 0
    v_mov_b32 v118, 0
K2_once:
    s_mov_b32 s37, s36
    s_cmp_eq_u32 s36, 0
    s_cbranch_scc1 K2_done
    ds_read_b128 v[120:123], v119
    ds_read_b128 v[124:127], v119
    ds_read_b128 v[128:131], v119
    ds_read_b128 v[136:139], v119
    ds_read_b128 v[140:143], v119
    ds_read_b128 v[144:147], v119
    ds_read_b128 v[152:155], v119
    ds_read_b128 v[156:159], v119
    ds_read_b128 v[160:163], v119
    ds_read_b128 v[168:171], v119
    ds_read_b128 v[172:175], v119
    ds_read_b128 v[176:179], v119
    s_waitcnt lgkmcnt(8)
    ds_read_b128 v[184:187], v103
    ds_read_b32 v250, v109 offset:320
    ds_read_b128 v[188:191], v111 offset:0
    ds_read_b128 v[192:195], v111 offset:1024
    s_mov_b32 s42, 0
    s_add_u32 s86, s39, 8192
    s_mov_b32 s46, 0
    s_waitcnt vmcnt(5)
    ds_read_b128 v[200:203], v107
    ds_read_b32 v252, v105 offset:140
    s_cmp_lt_u32 s33, 4
    s_cselect_b64 vcc, -1, 0
    s_setprio 1
    s_set_gpr_idx_on s46, 0xc
    s_waitcnt lgkmcnt(0)
    v_mov_b64 v[132:133], 0
    v_mov_b64 v[134:135], 0
    ds_read_b128 v[148:151], v119
    ds_read_b128 v[164:167], v119
    ds_read_b128 v[180:183], v119
    ds_read_b128 v[228:231], v111 offset:2048
    ds_read_b128 v[232:235], v111 offset:3072
    ds_read_b128 v[196:199], v119
    v_smfmac_f32_32x32x32_bf16 v[120:135], v[200:203], v[188:195], v119 abid:1
    v_perm_b32 v240, v186, v184, v113
    v_perm_b32 v241, v185, v184, v115
    v_perm_b32 v243, v185, v184, v117
    ds_read_b128 v[184:187], v119
    ds_read_b128 v[188:191], v119
    ds_read_b128 v[192:195], v119
    s_waitcnt lgkmcnt(8)
    v_smfmac_f32_32x32x32_bf16 v[136:151], v[200:203], v[204:211], v119 abid:1
    v_readlane_b32 s48, v250, 0
    v_readlane_b32 s49, v250, 2
    v_readlane_b32 s50, v250, 4
    v_readlane_b32 s51, v250, 6
    s_waitcnt lgkmcnt(7)
    v_smfmac_f32_32x32x32_bf16 v[152:167], v[200:203], v[212:219], v119 abid:1
    v_readlane_b32 s52, v250, 8
    v_readlane_b32 s53, v250, 10
    v_readlane_b32 s54, v250, 12
    v_readlane_b32 s55, v250, 14
    s_waitcnt lgkmcnt(4)
    v_smfmac_f32_32x32x32_bf16 v[168:183], v[200:203], v[228:235], v119 abid:1
    s_add_u32 s42, s42, 512
    s_and_b32 s42, s42, 0x7ff
    s_xor_b32 s89, s42, 1024
    s_add_u32 s89, s89, s41
    s_waitcnt lgkmcnt(0)
    v_smfmac_f32_32x32x32_bf16 v[184:199], v[200:203], v[220:227], v119 abid:1
    v_add_u32 v251, s42, v107
    v_add_u32 v103, 352, v103
    v_add_u32 v109, 352, v109
    s_add_u32 s38, s86, 4096
    s_cmp_eq_u32 s38, s40
    s_cselect_b32 s38, s39, s38
    s_add_u32 s86, s38, 4096
    s_cmp_eq_u32 s86, s40
    s_cselect_b32 s86, s39, s86
    s_sub_u32 s87, s86, s38
    s_add_u32 s88, s86, 4096
    s_cmp_eq_u32 s88, s40
    s_cselect_b32 s88, s39, s88
    s_sub_u32 s88, s88, s86
    s_waitcnt vmcnt(4)
    ds_read_b64_tr_b16 v[246:247], v101 offset:0
    s_add_u32 m0, s39, 4096
    ds_read_b64_tr_b16 v[248:249], v101 offset:512
    s_waitcnt lgkmcnt(1) vmcnt(2)
    buffer_load_dwordx4 v[252:253], s[4:7], 0 idxen offen lds
    v_mfma_f32_4x4x4_16b_bf16 v[228:231], v[240:241], v[246:247], 0 cbsz:4 abid:0
    v_mfma_f32_4x4x4_16b_bf16 v[232:235], v[242:243], v[246:247], 0 cbsz:4 abid:0
    v_mfma_f32_4x4x4_16b_bf16 v[236:239], v[244:245], v[246:247], 0 cbsz:4 abid:0
    s_mov_b32 m0, s48
    ds_read_b32 v252, v105 offset:172
    s_cbranch_vccz K2_yp1
    s_setprio 0
K2_yp1:
    s_nop 0
    v_pk_fma_f32 v[40:41], v[120:121], v[228:229], v[40:41] op_sel:[0,0,0] op_sel_hi:[0,1,1] neg_hi:[1,0,0]
    v_pk_fma_f32 v[20:21], v[136:137], v[232:233], v[20:21] op_sel:[0,0,0] op_sel_hi:[0,1,1]
    v_pk_fma_f32 v[0:1], v[152:153], v[236:237], v[0:1] op_sel:[0,0,0] op_sel_hi:[0,1,1]
    v_fmac_f32 v100, v231, v120
    v_fmac_f32 v61, v230, v168
    v_fmac_f32 v81, v234, v136
    v_fmac_f32 v60, v235, v184
    v_fmac_f32 v80, v238, v152
    s_add_u32 m0, s39, 5120
    ds_read_b64_tr_b16 v[246:247], v101 offset:1024
    s_waitcnt lgkmcnt(1)
    buffer_load_dwordx4 v[252:253], s[4:7], 0 idxen offen lds
    v_mfma_f32_4x4x4_16b_bf16 v[228:231], v[240:241], v[248:249], 0 cbsz:4 abid:1
    v_mfma_f32_4x4x4_16b_bf16 v[232:235], v[242:243], v[248:249], 0 cbsz:4 abid:1
    v_mfma_f32_4x4x4_16b_bf16 v[236:239], v[244:245], v[248:249], 0 cbsz:4 abid:1
    s_lshr_b32 m0, s48, 16
    ds_read_b32 v252, v105 offset:204
    ds_read_b32 v254, v109 offset:608
    ds_read_b32 v250, v109 offset:320
    v_pk_fma_f32 v[40:41], v[120:121], v[228:229], v[40:41] op_sel:[1,0,0] op_sel_hi:[1,1,1] neg_hi:[1,0,0]
    v_pk_fma_f32 v[20:21], v[136:137], v[232:233], v[20:21] op_sel:[1,0,0] op_sel_hi:[1,1,1]
    v_pk_fma_f32 v[0:1], v[152:153], v[236:237], v[0:1] op_sel:[1,0,0] op_sel_hi:[1,1,1]
    v_fmac_f32 v100, v231, v121
    v_fmac_f32 v61, v230, v169
    v_fmac_f32 v81, v234, v137
    v_fmac_f32 v60, v235, v185
    v_fmac_f32 v80, v238, v153
    s_add_u32 m0, s39, 6144
    ds_read_b64_tr_b16 v[248:249], v101 offset:1536
    s_waitcnt lgkmcnt(3) vmcnt(3)
    buffer_load_dwordx4 v[252:253], s[4:7], 0 idxen offen lds
    v_mfma_f32_4x4x4_16b_bf16 v[228:231], v[240:241], v[246:247], 0 cbsz:4 abid:2
    v_mfma_f32_4x4x4_16b_bf16 v[232:235], v[242:243], v[246:247], 0 cbsz:4 abid:2
    v_mfma_f32_4x4x4_16b_bf16 v[236:239], v[244:245], v[246:247], 0 cbsz:4 abid:2
    s_mov_b32 m0, s49
    ds_read_b32 v252, v105 offset:236
    ds_read_b128 v[200:203], v251
    v_pk_fma_f32 v[40:41], v[122:123], v[228:229], v[40:41] op_sel:[0,0,0] op_sel_hi:[0,1,1] neg_hi:[1,0,0]
    v_pk_fma_f32 v[20:21], v[138:139], v[232:233], v[20:21] op_sel:[0,0,0] op_sel_hi:[0,1,1]
    v_pk_fma_f32 v[0:1], v[154:155], v[236:237], v[0:1] op_sel:[0,0,0] op_sel_hi:[0,1,1]
    v_fmac_f32 v100, v231, v122
    v_fmac_f32 v61, v230, v170
    v_fmac_f32 v81, v234, v138
    v_fmac_f32 v60, v235, v186
    v_fmac_f32 v80, v238, v154
    s_add_u32 m0, s39, 7168
    ds_read_b64_tr_b16 v[246:247], v101 offset:2048
    s_waitcnt lgkmcnt(2)
    buffer_load_dwordx4 v[252:253], s[4:7], 0 idxen offen lds
    v_mfma_f32_4x4x4_16b_bf16 v[228:231], v[240:241], v[248:249], 0 cbsz:4 abid:3
    v_mfma_f32_4x4x4_16b_bf16 v[232:235], v[242:243], v[248:249], 0 cbsz:4 abid:3
    v_mfma_f32_4x4x4_16b_bf16 v[236:239], v[244:245], v[248:249], 0 cbsz:4 abid:3
    s_lshr_b32 m0, s49, 16
    ds_read_b32 v252, v105 offset:364
    s_nop 0
    v_pk_fma_f32 v[40:41], v[122:123], v[228:229], v[40:41] op_sel:[1,0,0] op_sel_hi:[1,1,1] neg_hi:[1,0,0]
    v_pk_fma_f32 v[20:21], v[138:139], v[232:233], v[20:21] op_sel:[1,0,0] op_sel_hi:[1,1,1]
    v_pk_fma_f32 v[0:1], v[154:155], v[236:237], v[0:1] op_sel:[1,0,0] op_sel_hi:[1,1,1]
    v_fmac_f32 v100, v231, v123
    v_fmac_f32 v61, v230, v171
    v_fmac_f32 v81, v234, v139
    v_fmac_f32 v60, v235, v187
    v_fmac_f32 v80, v238, v155
    s_add_u32 m0, s39, 8192
    ds_read_b64_tr_b16 v[248:249], v101 offset:2560
    s_waitcnt lgkmcnt(1) vmcnt(4)
    s_cmp_le_u32 s37, 4
    s_cbranch_scc1 K2_exit
    buffer_load_dwordx4 v[252:253], s[4:7], 0 idxen offen lds
    s_add_u32 m0, s41, 1024
    s_nop 0
    buffer_load_dwordx4 v[254:255], s[8:11], 0 idxen offen lds
    v_mfma_f32_4x4x4_16b_bf16 v[228:231], v[240:241], v[246:247], 0 cbsz:4 abid:4
    v_mfma_f32_4x4x4_16b_bf16 v[232:235], v[242:243], v[246:247], 0 cbsz:4 abid:4
    v_mfma_f32_4x4x4_16b_bf16 v[236:239], v[244:245], v[246:247], 0 cbsz:4 abid:4
    s_mov_b32 m0, s50
    ds_read_b32 v252, v105 offset:396
    ds_read_b128 v[184:187], v103
    ds_read_b128 v[120:123], v119
    v_pk_fma_f32 v[40:41], v[124:125], v[228:229], v[40:41] op_sel:[0,0,0] op_sel_hi:[0,1,1] neg_hi:[1,0,0]
    v_pk_fma_f32 v[20:21], v[140:141], v[232:233], v[20:21] op_sel:[0,0,0] op_sel_hi:[0,1,1]
    v_pk_fma_f32 v[0:1], v[156:157], v[236:237], v[0:1] op_sel:[0,0,0] op_sel_hi:[0,1,1]
    v_fmac_f32 v100, v231, v124
    v_fmac_f32 v61, v230, v172
    v_fmac_f32 v81, v234, v140
    v_fmac_f32 v60, v235, v188
    v_fmac_f32 v80, v238, v156
    s_add_u32 m0, s39, 9216
    ds_read_b64_tr_b16 v[246:247], v101 offset:3072
    s_waitcnt lgkmcnt(3)
    buffer_load_dwordx4 v[252:253], s[4:7], 0 idxen offen lds
    v_mfma_f32_4x4x4_16b_bf16 v[228:231], v[240:241], v[248:249], 0 cbsz:4 abid:5
    v_mfma_f32_4x4x4_16b_bf16 v[232:235], v[242:243], v[248:249], 0 cbsz:4 abid:5
    v_mfma_f32_4x4x4_16b_bf16 v[236:239], v[244:245], v[248:249], 0 cbsz:4 abid:5
    s_lshr_b32 m0, s50, 16
    ds_read_b32 v252, v105 offset:428
    ds_read_b128 v[136:139], v119
    v_pk_fma_f32 v[40:41], v[124:125], v[228:229], v[40:41] op_sel:[1,0,0] op_sel_hi:[1,1,1] neg_hi:[1,0,0]
    v_pk_fma_f32 v[20:21], v[140:141], v[232:233], v[20:21] op_sel:[1,0,0] op_sel_hi:[1,1,1]
    v_pk_fma_f32 v[0:1], v[156:157], v[236:237], v[0:1] op_sel:[1,0,0] op_sel_hi:[1,1,1]
    v_fmac_f32 v100, v231, v125
    v_fmac_f32 v61, v230, v173
    v_fmac_f32 v81, v234, v141
    v_fmac_f32 v60, v235, v189
    v_fmac_f32 v80, v238, v157
    s_add_u32 m0, s39, 10240
    ds_read_b64_tr_b16 v[248:249], v101 offset:3584
    s_waitcnt lgkmcnt(2) vmcnt(6)
    v_add_u32 v101, s87, v101
    buffer_load_dwordx4 v[252:253], s[4:7], 0 idxen offen lds
    v_mfma_f32_4x4x4_16b_bf16 v[228:231], v[240:241], v[246:247], 0 cbsz:4 abid:6
    v_mfma_f32_4x4x4_16b_bf16 v[232:235], v[242:243], v[246:247], 0 cbsz:4 abid:6
    v_mfma_f32_4x4x4_16b_bf16 v[236:239], v[244:245], v[246:247], 0 cbsz:4 abid:6
    s_mov_b32 m0, s51
    ds_read_b32 v252, v105 offset:460
    ds_read_b32 v254, v109 offset:960
    ds_read_b128 v[152:155], v119
    ds_read_b128 v[168:171], v119
    v_pk_fma_f32 v[40:41], v[126:127], v[228:229], v[40:41] op_sel:[0,0,0] op_sel_hi:[0,1,1] neg_hi:[1,0,0]
    v_pk_fma_f32 v[20:21], v[142:143], v[232:233], v[20:21] op_sel:[0,0,0] op_sel_hi:[0,1,1]
    v_pk_fma_f32 v[0:1], v[158:159], v[236:237], v[0:1] op_sel:[0,0,0] op_sel_hi:[0,1,1]
    v_fmac_f32 v100, v231, v126
    v_fmac_f32 v61, v230, v174
    v_fmac_f32 v81, v234, v142
    v_fmac_f32 v60, v235, v190
    v_fmac_f32 v80, v238, v158
    s_add_u32 m0, s39, 11264
    ds_read_b64_tr_b16 v[246:247], v101 offset:0
    s_waitcnt lgkmcnt(4)
    buffer_load_dwordx4 v[252:253], s[4:7], 0 idxen offen lds
    v_mfma_f32_4x4x4_16b_bf16 v[228:231], v[240:241], v[248:249], 0 cbsz:4 abid:7
    v_mfma_f32_4x4x4_16b_bf16 v[232:235], v[242:243], v[248:249], 0 cbsz:4 abid:7
    v_mfma_f32_4x4x4_16b_bf16 v[236:239], v[244:245], v[248:249], 0 cbsz:4 abid:7
    s_lshr_b32 m0, s51, 16
    ds_read_b32 v252, v105 offset:492
    s_nop 0
    v_pk_fma_f32 v[40:41], v[126:127], v[228:229], v[40:41] op_sel:[1,0,0] op_sel_hi:[1,1,1] neg_hi:[1,0,0]
    v_pk_fma_f32 v[20:21], v[142:143], v[232:233], v[20:21] op_sel:[1,0,0] op_sel_hi:[1,1,1]
    v_pk_fma_f32 v[0:1], v[158:159], v[236:237], v[0:1] op_sel:[1,0,0] op_sel_hi:[1,1,1]
    v_fmac_f32 v100, v231, v127
    v_fmac_f32 v61, v230, v175
    v_fmac_f32 v81, v234, v143
    v_fmac_f32 v60, v235, v191
    v_fmac_f32 v80, v238, v159
    s_add_u32 m0, s39, 0
    ds_read_b64_tr_b16 v[248:249], v101 offset:512
    s_waitcnt lgkmcnt(1) vmcnt(7)
    s_cmp_le_u32 s37, 8
    s_cbranch_scc1 K2_exit
    buffer_load_dwordx4 v[252:253], s[4:7], 0 idxen offen lds
    v_mfma_f32_4x4x4_16b_bf16 v[228:231], v[240:241], v[246:247], 0 cbsz:4 abid:8
    v_mfma_f32_4x4x4_16b_bf16 v[232:235], v[242:243], v[246:247], 0 cbsz:4 abid:8
    v_mfma_f32_4x4x4_16b_bf16 v[236:239], v[244:245], v[246:247], 0 cbsz:4 abid:8
    s_mov_b32 m0, s52
    ds_read_b32 v252, v105 offset:524
    ds_read_b128 v[124:127], v119
    ds_read_b128 v[140:143], v119
    v_pk_fma_f32 v[40:41], v[128:129], v[228:229], v[40:41] op_sel:[0,0,0] op_sel_hi:[0,1,1] neg_hi:[1,0,0]
    v_pk_fma_f32 v[20:21], v[144:145], v[232:233], v[20:21] op_sel:[0,0,0] op_sel_hi:[0,1,1]
    v_pk_fma_f32 v[0:1], v[160:161], v[236:237], v[0:1] op_sel:[0,0,0] op_sel_hi:[0,1,1]
    v_fmac_f32 v100, v231, v128
    v_fmac_f32 v61, v230, v176
    v_fmac_f32 v81, v234, v144
    v_fmac_f32 v60, v235, v192
    v_fmac_f32 v80, v238, v160
    s_add_u32 m0, s39, 1024
    ds_read_b64_tr_b16 v[246:247], v101 offset:1024
    s_waitcnt lgkmcnt(3)
    buffer_load_dwordx4 v[252:253], s[4:7], 0 idxen offen lds
    v_mfma_f32_4x4x4_16b_bf16 v[228:231], v[240:241], v[248:249], 0 cbsz:4 abid:9
    v_mfma_f32_4x4x4_16b_bf16 v[232:235], v[242:243], v[248:249], 0 cbsz:4 abid:9
    v_mfma_f32_4x4x4_16b_bf16 v[236:239], v[244:245], v[248:249], 0 cbsz:4 abid:9
    s_lshr_b32 m0, s52, 16
    ds_read_b32 v252, v105 offset:556
    s_nop 0
    v_pk_fma_f32 v[40:41], v[128:129], v[228:229], v[40:41] op_sel:[1,0,0] op_sel_hi:[1,1,1] neg_hi:[1,0,0]
    v_pk_fma_f32 v[20:21], v[144:145], v[232:233], v[20:21] op_sel:[1,0,0] op_sel_hi:[1,1,1]
    v_pk_fma_f32 v[0:1], v[160:161], v[236:237], v[0:1] op_sel:[1,0,0] op_sel_hi:[1,1,1]
    v_fmac_f32 v100, v231, v129
    v_fmac_f32 v61, v230, v177
    v_fmac_f32 v81, v234, v145
    v_fmac_f32 v60, v235, v193
    v_fmac_f32 v80, v238, v161
    s_add_u32 m0, s39, 2048
    ds_read_b64_tr_b16 v[248:249], v101 offset:1536
    s_waitcnt lgkmcnt(1) vmcnt(8)
    buffer_load_dwordx4 v[252:253], s[4:7], 0 idxen offen lds
    v_mfma_f32_4x4x4_16b_bf16 v[228:231], v[240:241], v[246:247], 0 cbsz:4 abid:10
    v_mfma_f32_4x4x4_16b_bf16 v[232:235], v[242:243], v[246:247], 0 cbsz:4 abid:10
    v_mfma_f32_4x4x4_16b_bf16 v[236:239], v[244:245], v[246:247], 0 cbsz:4 abid:10
    s_mov_b32 m0, s53
    ds_read_b32 v252, v105 offset:588
    ds_read_b128 v[156:159], v119
    ds_read_b128 v[172:175], v119
    v_pk_fma_f32 v[40:41], v[130:131], v[228:229], v[40:41] op_sel:[0,0,0] op_sel_hi:[0,1,1] neg_hi:[1,0,0]
    v_pk_fma_f32 v[20:21], v[146:147], v[232:233], v[20:21] op_sel:[0,0,0] op_sel_hi:[0,1,1]
    v_pk_fma_f32 v[0:1], v[162:163], v[236:237], v[0:1] op_sel:[0,0,0] op_sel_hi:[0,1,1]
    v_fmac_f32 v100, v231, v130
    v_fmac_f32 v61, v230, v178
    v_fmac_f32 v81, v234, v146
    v_fmac_f32 v60, v235, v194
    v_fmac_f32 v80, v238, v162
    s_add_u32 m0, s39, 3072
    ds_read_b64_tr_b16 v[246:247], v101 offset:2048
    s_waitcnt lgkmcnt(3)
    buffer_load_dwordx4 v[252:253], s[4:7], 0 idxen offen lds
    v_mfma_f32_4x4x4_16b_bf16 v[228:231], v[240:241], v[248:249], 0 cbsz:4 abid:11
    v_mfma_f32_4x4x4_16b_bf16 v[232:235], v[242:243], v[248:249], 0 cbsz:4 abid:11
    v_mfma_f32_4x4x4_16b_bf16 v[236:239], v[244:245], v[248:249], 0 cbsz:4 abid:11
    s_lshr_b32 m0, s53, 16
    ds_read_b32 v252, v105 offset:716
    s_setprio 1
    v_pk_fma_f32 v[40:41], v[130:131], v[228:229], v[40:41] op_sel:[1,0,0] op_sel_hi:[1,1,1] neg_hi:[1,0,0]
    v_pk_fma_f32 v[20:21], v[146:147], v[232:233], v[20:21] op_sel:[1,0,0] op_sel_hi:[1,1,1]
    v_pk_fma_f32 v[0:1], v[162:163], v[236:237], v[0:1] op_sel:[1,0,0] op_sel_hi:[1,1,1]
    v_fmac_f32 v100, v231, v131
    v_fmac_f32 v61, v230, v179
    v_fmac_f32 v81, v234, v147
    v_fmac_f32 v60, v235, v195
    v_fmac_f32 v80, v238, v163
    s_add_u32 m0, s39, 4096
    ds_read_b64_tr_b16 v[248:249], v101 offset:2560
    s_waitcnt lgkmcnt(1) vmcnt(9)
    s_cmp_le_u32 s37, 12
    s_cbranch_scc1 K2_exit
    buffer_load_dwordx4 v[252:253], s[4:7], 0 idxen offen lds
    s_add_u32 m0, s41, 1536
    s_nop 0
    buffer_load_dwordx4 v[254:255], s[8:11], 0 idxen offen lds
    v_mfma_f32_4x4x4_16b_bf16 v[228:231], v[240:241], v[246:247], 0 cbsz:4 abid:12
    v_mfma_f32_4x4x4_16b_bf16 v[232:235], v[242:243], v[246:247], 0 cbsz:4 abid:12
    v_mfma_f32_4x4x4_16b_bf16 v[236:239], v[244:245], v[246:247], 0 cbsz:4 abid:12
    s_mov_b32 m0, s54
    ds_read_b32 v252, v105 offset:748
    ds_read_b128 v[188:191], v111 offset:0
    ds_read_b128 v[192:195], v111 offset:1024
    v_pk_fma_f32 v[40:41], v[132:133], v[228:229], v[40:41] op_sel:[0,0,0] op_sel_hi:[0,1,1] neg_hi:[1,0,0]
    v_pk_fma_f32 v[20:21], v[148:149], v[232:233], v[20:21] op_sel:[0,0,0] op_sel_hi:[0,1,1]
    v_pk_fma_f32 v[0:1], v[164:165], v[236:237], v[0:1] op_sel:[0,0,0] op_sel_hi:[0,1,1]
    v_fmac_f32 v100, v231, v132
    v_fmac_f32 v61, v230, v180
    v_fmac_f32 v81, v234, v148
    v_fmac_f32 v60, v235, v196
    v_fmac_f32 v80, v238, v164
    s_add_u32 m0, s39, 5120
    ds_read_b64_tr_b16 v[246:247], v101 offset:3072
    s_waitcnt lgkmcnt(3)
    buffer_load_dwordx4 v[252:253], s[4:7], 0 idxen offen lds
    v_mfma_f32_4x4x4_16b_bf16 v[228:231], v[240:241], v[248:249], 0 cbsz:4 abid:13
    v_mfma_f32_4x4x4_16b_bf16 v[232:235], v[242:243], v[248:249], 0 cbsz:4 abid:13
    v_mfma_f32_4x4x4_16b_bf16 v[236:239], v[244:245], v[248:249], 0 cbsz:4 abid:13
    s_lshr_b32 m0, s54, 16
    ds_read_b32 v252, v105 offset:780
    ds_read_b128 v[128:131], v119
    v_pk_fma_f32 v[40:41], v[132:133], v[228:229], v[40:41] op_sel:[1,0,0] op_sel_hi:[1,1,1] neg_hi:[1,0,0]
    v_pk_fma_f32 v[20:21], v[148:149], v[232:233], v[20:21] op_sel:[1,0,0] op_sel_hi:[1,1,1]
    v_pk_fma_f32 v[0:1], v[164:165], v[236:237], v[0:1] op_sel:[1,0,0] op_sel_hi:[1,1,1]
    v_fmac_f32 v100, v231, v133
    v_fmac_f32 v61, v230, v181
    v_fmac_f32 v81, v234, v149
    v_fmac_f32 v60, v235, v197
    v_fmac_f32 v80, v238, v165
    s_add_u32 m0, s39, 6144
    ds_read_b64_tr_b16 v[248:249], v101 offset:3584
    s_waitcnt lgkmcnt(2) vmcnt(11)
    v_add_u32 v101, s88, v101
    buffer_load_dwordx4 v[252:253], s[4:7], 0 idxen offen lds
    v_mfma_f32_4x4x4_16b_bf16 v[228:231], v[240:241], v[246:247], 0 cbsz:4 abid:14
    v_mfma_f32_4x4x4_16b_bf16 v[232:235], v[242:243], v[246:247], 0 cbsz:4 abid:14
    v_mfma_f32_4x4x4_16b_bf16 v[236:239], v[244:245], v[246:247], 0 cbsz:4 abid:14
    s_mov_b32 m0, s55
    ds_read_b32 v252, v105 offset:812
    ds_read_b128 v[144:147], v119
    ds_read_b128 v[160:163], v119
    v_pk_fma_f32 v[40:41], v[134:135], v[228:229], v[40:41] op_sel:[0,0,0] op_sel_hi:[0,1,1] neg_hi:[1,0,0]
    v_pk_fma_f32 v[20:21], v[150:151], v[232:233], v[20:21] op_sel:[0,0,0] op_sel_hi:[0,1,1]
    v_pk_fma_f32 v[0:1], v[166:167], v[236:237], v[0:1] op_sel:[0,0,0] op_sel_hi:[0,1,1]
    v_fmac_f32 v100, v231, v134
    v_fmac_f32 v61, v230, v182
    v_fmac_f32 v81, v234, v150
    v_fmac_f32 v60, v235, v198
    v_fmac_f32 v80, v238, v166
    s_add_u32 m0, s39, 7168
    ds_read_b64_tr_b16 v[246:247], v101 offset:0
    s_waitcnt lgkmcnt(3)
    buffer_load_dwordx4 v[252:253], s[4:7], 0 idxen offen lds
    v_mfma_f32_4x4x4_16b_bf16 v[228:231], v[240:241], v[248:249], 0 cbsz:4 abid:15
    v_mfma_f32_4x4x4_16b_bf16 v[232:235], v[242:243], v[248:249], 0 cbsz:4 abid:15
    v_mfma_f32_4x4x4_16b_bf16 v[236:239], v[244:245], v[248:249], 0 cbsz:4 abid:15
    s_lshr_b32 m0, s55, 16
    ds_read_b32 v252, v105 offset:844
    ds_read_b128 v[176:179], v119
    v_pk_fma_f32 v[40:41], v[134:135], v[228:229], v[40:41] op_sel:[1,0,0] op_sel_hi:[1,1,1] neg_hi:[1,0,0]
    v_pk_fma_f32 v[20:21], v[150:151], v[232:233], v[20:21] op_sel:[1,0,0] op_sel_hi:[1,1,1]
    v_pk_fma_f32 v[0:1], v[166:167], v[236:237], v[0:1] op_sel:[1,0,0] op_sel_hi:[1,1,1]
    v_fmac_f32 v100, v231, v135
    v_fmac_f32 v61, v230, v183
    v_fmac_f32 v81, v234, v151
    v_fmac_f32 v60, v235, v199
    v_fmac_f32 v80, v238, v167
    s_mov_b32 m0, 0
    s_sub_u32 s37, s37, 16
    v_add_u32 v105, 352, v105
    s_cmp_le_i32 s37, 0
    s_cbranch_scc1 K2_exit
    .p2align 6
K2_tile:
    v_mov_b64 v[132:133], 0
    v_mov_b64 v[134:135], 0
    ds_read_b128 v[148:151], v119
    ds_read_b128 v[164:167], v119
    ds_read_b128 v[180:183], v119
    ds_read_b128 v[228:231], v111 offset:2048
    ds_read_b128 v[232:235], v111 offset:3072
    ds_read_b128 v[196:199], v119
    v_smfmac_f32_32x32x32_bf16 v[120:135], v[200:203], v[188:195], v119 abid:1
    v_perm_b32 v240, v186, v184, v113
    v_perm_b32 v241, v185, v184, v115
    v_perm_b32 v243, v185, v184, v117
    ds_read_b128 v[184:187], v119
    ds_read_b128 v[188:191], v119
    ds_read_b128 v[192:195], v119
    s_waitcnt lgkmcnt(8)
    v_smfmac_f32_32x32x32_bf16 v[136:151], v[200:203], v[204:211], v119 abid:1
    v_readlane_b32 s48, v250, 0
    v_readlane_b32 s49, v250, 2
    v_readlane_b32 s50, v250, 4
    v_readlane_b32 s51, v250, 6
    s_waitcnt lgkmcnt(7)
    v_smfmac_f32_32x32x32_bf16 v[152:167], v[200:203], v[212:219], v119 abid:1
    v_readlane_b32 s52, v250, 8
    v_readlane_b32 s53, v250, 10
    v_readlane_b32 s54, v250, 12
    v_readlane_b32 s55, v250, 14
    s_waitcnt lgkmcnt(4)
    v_smfmac_f32_32x32x32_bf16 v[168:183], v[200:203], v[228:235], v119 abid:1
    s_add_u32 s42, s42, 512
    s_and_b32 s42, s42, 0x7ff
    s_xor_b32 s89, s42, 1024
    s_add_u32 s89, s89, s41
    s_waitcnt lgkmcnt(0)
    v_smfmac_f32_32x32x32_bf16 v[184:199], v[200:203], v[220:227], v119 abid:1
    v_add_u32 v251, s42, v107
    v_add_u32 v103, 352, v103
    v_add_u32 v105, 352, v105
    v_add_u32 v109, 352, v109
    s_add_u32 s38, s86, 4096
    s_cmp_eq_u32 s38, s40
    s_cselect_b32 s38, s39, s38
    s_add_u32 s86, s38, 4096
    s_cmp_eq_u32 s86, s40
    s_cselect_b32 s86, s39, s86
    s_sub_u32 s87, s86, s38
    s_add_u32 s88, s86, 4096
    s_cmp_eq_u32 s88, s40
    s_cselect_b32 s88, s39, s88
    s_sub_u32 s88, s88, s86
    ds_read_b64_tr_b16 v[248:249], v101 offset:512
    s_waitcnt lgkmcnt(3) vmcnt(11)
    v_mfma_f32_4x4x4_16b_bf16 v[228:231], v[240:241], v[246:247], 0 cbsz:4 abid:0
    v_mfma_f32_4x4x4_16b_bf16 v[232:235], v[242:243], v[246:247], 0 cbsz:4 abid:0
    v_mfma_f32_4x4x4_16b_bf16 v[236:239], v[244:245], v[246:247], 0 cbsz:4 abid:0
    s_mov_b32 m0, s48
    s_cbranch_vccz K2_yp0
    s_setprio 0
K2_yp0:
    s_nop 0
    v_pk_fma_f32 v[40:41], v[120:121], v[228:229], v[40:41] op_sel:[0,0,0] op_sel_hi:[0,1,1] neg_hi:[1,0,0]
    v_pk_fma_f32 v[20:21], v[136:137], v[232:233], v[20:21] op_sel:[0,0,0] op_sel_hi:[0,1,1]
    v_pk_fma_f32 v[0:1], v[152:153], v[236:237], v[0:1] op_sel:[0,0,0] op_sel_hi:[0,1,1]
    v_fmac_f32 v100, v231, v120
    v_fmac_f32 v61, v230, v168
    v_fmac_f32 v81, v234, v136
    v_fmac_f32 v60, v235, v184
    v_fmac_f32 v80, v238, v152
    s_add_u32 m0, s38, 0
    ds_read_b64_tr_b16 v[246:247], v101 offset:1024
    s_waitcnt lgkmcnt(1)
    buffer_load_dwordx4 v[252:253], s[4:7], 0 idxen offen lds
    v_mfma_f32_4x4x4_16b_bf16 v[228:231], v[240:241], v[248:249], 0 cbsz:4 abid:1
    v_mfma_f32_4x4x4_16b_bf16 v[232:235], v[242:243], v[248:249], 0 cbsz:4 abid:1
    v_mfma_f32_4x4x4_16b_bf16 v[236:239], v[244:245], v[248:249], 0 cbsz:4 abid:1
    s_lshr_b32 m0, s48, 16
    ds_read_b32 v252, v105 offset:172
    ds_read_b32 v250, v109 offset:320
    v_pk_fma_f32 v[40:41], v[120:121], v[228:229], v[40:41] op_sel:[1,0,0] op_sel_hi:[1,1,1] neg_hi:[1,0,0]
    v_pk_fma_f32 v[20:21], v[136:137], v[232:233], v[20:21] op_sel:[1,0,0] op_sel_hi:[1,1,1]
    v_pk_fma_f32 v[0:1], v[152:153], v[236:237], v[0:1] op_sel:[1,0,0] op_sel_hi:[1,1,1]
    v_fmac_f32 v100, v231, v121
    v_fmac_f32 v61, v230, v169
    v_fmac_f32 v81, v234, v137
    v_fmac_f32 v60, v235, v185
    v_fmac_f32 v80, v238, v153
    s_mov_b32 m0, 0
    ds_read_b64_tr_b16 v[248:249], v101 offset:1536
    s_waitcnt lgkmcnt(3) vmcnt(11)
    s_nop 0
    v_mfma_f32_4x4x4_16b_bf16 v[228:231], v[240:241], v[246:247], 0 cbsz:4 abid:2
    v_mfma_f32_4x4x4_16b_bf16 v[232:235], v[242:243], v[246:247], 0 cbsz:4 abid:2
    v_mfma_f32_4x4x4_16b_bf16 v[236:239], v[244:245], v[246:247], 0 cbsz:4 abid:2
    s_mov_b32 m0, s49
    ds_read_b128 v[200:203], v251
    ds_read_b32 v254, v109 offset:960
    v_pk_fma_f32 v[40:41], v[122:123], v[228:229], v[40:41] op_sel:[0,0,0] op_sel_hi:[0,1,1] neg_hi:[1,0,0]
    v_pk_fma_f32 v[20:21], v[138:139], v[232:233], v[20:21] op_sel:[0,0,0] op_sel_hi:[0,1,1]
    v_pk_fma_f32 v[0:1], v[154:155], v[236:237], v[0:1] op_sel:[0,0,0] op_sel_hi:[0,1,1]
    v_fmac_f32 v100, v231, v122
    v_fmac_f32 v61, v230, v170
    v_fmac_f32 v81, v234, v138
    v_fmac_f32 v60, v235, v186
    v_fmac_f32 v80, v238, v154
    s_add_u32 m0, s38, 1024
    ds_read_b64_tr_b16 v[246:247], v101 offset:2048
    s_waitcnt lgkmcnt(3)
    buffer_load_dwordx4 v[252:253], s[4:7], 0 idxen offen lds
    v_mfma_f32_4x4x4_16b_bf16 v[228:231], v[240:241], v[248:249], 0 cbsz:4 abid:3
    v_mfma_f32_4x4x4_16b_bf16 v[232:235], v[242:243], v[248:249], 0 cbsz:4 abid:3
    v_mfma_f32_4x4x4_16b_bf16 v[236:239], v[244:245], v[248:249], 0 cbsz:4 abid:3
    s_lshr_b32 m0, s49, 16
    ds_read_b32 v252, v105 offset:204
    s_cmp_le_u32 s37, 4
    v_pk_fma_f32 v[40:41], v[122:123], v[228:229], v[40:41] op_sel:[1,0,0] op_sel_hi:[1,1,1] neg_hi:[1,0,0]
    v_pk_fma_f32 v[20:21], v[138:139], v[232:233], v[20:21] op_sel:[1,0,0] op_sel_hi:[1,1,1]
    v_pk_fma_f32 v[0:1], v[154:155], v[236:237], v[0:1] op_sel:[1,0,0] op_sel_hi:[1,1,1]
    v_fmac_f32 v100, v231, v123
    v_fmac_f32 v61, v230, v171
    v_fmac_f32 v81, v234, v139
    v_fmac_f32 v60, v235, v187
    v_fmac_f32 v80, v238, v155
    s_mov_b32 m0, 0
    ds_read_b64_tr_b16 v[248:249], v101 offset:2560
    s_waitcnt lgkmcnt(2) vmcnt(11)
    s_cbranch_scc1 K2_exit
    v_mfma_f32_4x4x4_16b_bf16 v[228:231], v[240:241], v[246:247], 0 cbsz:4 abid:4
    v_mfma_f32_4x4x4_16b_bf16 v[232:235], v[242:243], v[246:247], 0 cbsz:4 abid:4
    v_mfma_f32_4x4x4_16b_bf16 v[236:239], v[244:245], v[246:247], 0 cbsz:4 abid:4
    s_mov_b32 m0, s50
    ds_read_b128 v[184:187], v103
    ds_read_b128 v[120:123], v119
    v_pk_fma_f32 v[40:41], v[124:125], v[228:229], v[40:41] op_sel:[0,0,0] op_sel_hi:[0,1,1] neg_hi:[1,0,0]
    v_pk_fma_f32 v[20:21], v[140:141], v[232:233], v[20:21] op_sel:[0,0,0] op_sel_hi:[0,1,1]
    v_pk_fma_f32 v[0:1], v[156:157], v[236:237], v[0:1] op_sel:[0,0,0] op_sel_hi:[0,1,1]
    v_fmac_f32 v100, v231, v124
    v_fmac_f32 v61, v230, v172
    v_fmac_f32 v81, v234, v140
    v_fmac_f32 v60, v235, v188
    v_fmac_f32 v80, v238, v156
    s_add_u32 m0, s38, 2048
    ds_read_b64_tr_b16 v[246:247], v101 offset:3072
    s_waitcnt lgkmcnt(3)
    buffer_load_dwordx4 v[252:253], s[4:7], 0 idxen offen lds
    v_mfma_f32_4x4x4_16b_bf16 v[228:231], v[240:241], v[248:249], 0 cbsz:4 abid:5
    v_mfma_f32_4x4x4_16b_bf16 v[232:235], v[242:243], v[248:249], 0 cbsz:4 abid:5
    v_mfma_f32_4x4x4_16b_bf16 v[236:239], v[244:245], v[248:249], 0 cbsz:4 abid:5
    s_lshr_b32 m0, s50, 16
    ds_read_b32 v252, v105 offset:236
    ds_read_b128 v[136:139], v119
    v_pk_fma_f32 v[40:41], v[124:125], v[228:229], v[40:41] op_sel:[1,0,0] op_sel_hi:[1,1,1] neg_hi:[1,0,0]
    v_pk_fma_f32 v[20:21], v[140:141], v[232:233], v[20:21] op_sel:[1,0,0] op_sel_hi:[1,1,1]
    v_pk_fma_f32 v[0:1], v[156:157], v[236:237], v[0:1] op_sel:[1,0,0] op_sel_hi:[1,1,1]
    v_fmac_f32 v100, v231, v125
    v_fmac_f32 v61, v230, v173
    v_fmac_f32 v81, v234, v141
    v_fmac_f32 v60, v235, v189
    v_fmac_f32 v80, v238, v157
    s_mov_b32 m0, 0
    ds_read_b64_tr_b16 v[248:249], v101 offset:3584
    s_waitcnt lgkmcnt(3) vmcnt(11)
    v_add_u32 v101, s87, v101
    v_mfma_f32_4x4x4_16b_bf16 v[228:231], v[240:241], v[246:247], 0 cbsz:4 abid:6
    v_mfma_f32_4x4x4_16b_bf16 v[232:235], v[242:243], v[246:247], 0 cbsz:4 abid:6
    v_mfma_f32_4x4x4_16b_bf16 v[236:239], v[244:245], v[246:247], 0 cbsz:4 abid:6
    s_mov_b32 m0, s51
    ds_read_b128 v[152:155], v119
    ds_read_b128 v[168:171], v119
    v_pk_fma_f32 v[40:41], v[126:127], v[228:229], v[40:41] op_sel:[0,0,0] op_sel_hi:[0,1,1] neg_hi:[1,0,0]
    v_pk_fma_f32 v[20:21], v[142:143], v[232:233], v[20:21] op_sel:[0,0,0] op_sel_hi:[0,1,1]
    v_pk_fma_f32 v[0:1], v[158:159], v[236:237], v[0:1] op_sel:[0,0,0] op_sel_hi:[0,1,1]
    v_fmac_f32 v100, v231, v126
    v_fmac_f32 v61, v230, v174
    v_fmac_f32 v81, v234, v142
    v_fmac_f32 v60, v235, v190
    v_fmac_f32 v80, v238, v158
    s_add_u32 m0, s38, 3072
    ds_read_b64_tr_b16 v[246:247], v101 offset:0
    s_waitcnt lgkmcnt(3)
    buffer_load_dwordx4 v[252:253], s[4:7], 0 idxen offen lds
    v_mfma_f32_4x4x4_16b_bf16 v[228:231], v[240:241], v[248:249], 0 cbsz:4 abid:7
    v_mfma_f32_4x4x4_16b_bf16 v[232:235], v[242:243], v[248:249], 0 cbsz:4 abid:7
    v_mfma_f32_4x4x4_16b_bf16 v[236:239], v[244:245], v[248:249], 0 cbsz:4 abid:7
    s_lshr_b32 m0, s51, 16
    ds_read_b32 v252, v105 offset:364
    s_cmp_le_u32 s37, 8
    v_pk_fma_f32 v[40:41], v[126:127], v[228:229], v[40:41] op_sel:[1,0,0] op_sel_hi:[1,1,1] neg_hi:[1,0,0]
    v_pk_fma_f32 v[20:21], v[142:143], v[232:233], v[20:21] op_sel:[1,0,0] op_sel_hi:[1,1,1]
    v_pk_fma_f32 v[0:1], v[158:159], v[236:237], v[0:1] op_sel:[1,0,0] op_sel_hi:[1,1,1]
    v_fmac_f32 v100, v231, v127
    v_fmac_f32 v61, v230, v175
    v_fmac_f32 v81, v234, v143
    v_fmac_f32 v60, v235, v191
    v_fmac_f32 v80, v238, v159
    s_mov_b32 m0, 0
    ds_read_b64_tr_b16 v[248:249], v101 offset:512
    s_waitcnt lgkmcnt(2) vmcnt(11)
    s_cbranch_scc1 K2_exit
    v_mfma_f32_4x4x4_16b_bf16 v[228:231], v[240:241], v[246:247], 0 cbsz:4 abid:8
    v_mfma_f32_4x4x4_16b_bf16 v[232:235], v[242:243], v[246:247], 0 cbsz:4 abid:8
    v_mfma_f32_4x4x4_16b_bf16 v[236:239], v[244:245], v[246:247], 0 cbsz:4 abid:8
    s_mov_b32 m0, s52
    ds_read_b128 v[124:127], v119
    ds_read_b128 v[140:143], v119
    v_pk_fma_f32 v[40:41], v[128:129], v[228:229], v[40:41] op_sel:[0,0,0] op_sel_hi:[0,1,1] neg_hi:[1,0,0]
    v_pk_fma_f32 v[20:21], v[144:145], v[232:233], v[20:21] op_sel:[0,0,0] op_sel_hi:[0,1,1]
    v_pk_fma_f32 v[0:1], v[160:161], v[236:237], v[0:1] op_sel:[0,0,0] op_sel_hi:[0,1,1]
    v_fmac_f32 v100, v231, v128
    v_fmac_f32 v61, v230, v176
    v_fmac_f32 v81, v234, v144
    v_fmac_f32 v60, v235, v192
    v_fmac_f32 v80, v238, v160
    s_add_u32 m0, s86, 0
    ds_read_b64_tr_b16 v[246:247], v101 offset:1024
    s_waitcnt lgkmcnt(3)
    buffer_load_dwordx4 v[252:253], s[4:7], 0 idxen offen lds
    v_mfma_f32_4x4x4_16b_bf16 v[228:231], v[240:241], v[248:249], 0 cbsz:4 abid:9
    v_mfma_f32_4x4x4_16b_bf16 v[232:235], v[242:243], v[248:249], 0 cbsz:4 abid:9
    v_mfma_f32_4x4x4_16b_bf16 v[236:239], v[244:245], v[248:249], 0 cbsz:4 abid:9
    s_lshr_b32 m0, s52, 16
    ds_read_b32 v252, v105 offset:396
    s_nop 0
    v_pk_fma_f32 v[40:41], v[128:129], v[228:229], v[40:41] op_sel:[1,0,0] op_sel_hi:[1,1,1] neg_hi:[1,0,0]
    v_pk_fma_f32 v[20:21], v[144:145], v[232:233], v[20:21] op_sel:[1,0,0] op_sel_hi:[1,1,1]
    v_pk_fma_f32 v[0:1], v[160:161], v[236:237], v[0:1] op_sel:[1,0,0] op_sel_hi:[1,1,1]
    v_fmac_f32 v100, v231, v129
    v_fmac_f32 v61, v230, v177
    v_fmac_f32 v81, v234, v145
    v_fmac_f32 v60, v235, v193
    v_fmac_f32 v80, v238, v161
    s_mov_b32 m0, s89
    ds_read_b64_tr_b16 v[248:249], v101 offset:1536
    s_waitcnt lgkmcnt(2) vmcnt(11)
    buffer_load_dwordx4 v[254:255], s[8:11], 0 idxen offen lds
    v_mfma_f32_4x4x4_16b_bf16 v[228:231], v[240:241], v[246:247], 0 cbsz:4 abid:10
    v_mfma_f32_4x4x4_16b_bf16 v[232:235], v[242:243], v[246:247], 0 cbsz:4 abid:10
    v_mfma_f32_4x4x4_16b_bf16 v[236:239], v[244:245], v[246:247], 0 cbsz:4 abid:10
    s_mov_b32 m0, s53
    ds_read_b128 v[156:159], v119
    ds_read_b128 v[172:175], v119
    v_pk_fma_f32 v[40:41], v[130:131], v[228:229], v[40:41] op_sel:[0,0,0] op_sel_hi:[0,1,1] neg_hi:[1,0,0]
    v_pk_fma_f32 v[20:21], v[146:147], v[232:233], v[20:21] op_sel:[0,0,0] op_sel_hi:[0,1,1]
    v_pk_fma_f32 v[0:1], v[162:163], v[236:237], v[0:1] op_sel:[0,0,0] op_sel_hi:[0,1,1]
    v_fmac_f32 v100, v231, v130
    v_fmac_f32 v61, v230, v178
    v_fmac_f32 v81, v234, v146
    v_fmac_f32 v60, v235, v194
    v_fmac_f32 v80, v238, v162
    s_add_u32 m0, s86, 1024
    ds_read_b64_tr_b16 v[246:247], v101 offset:2048
    s_waitcnt lgkmcnt(3)
    buffer_load_dwordx4 v[252:253], s[4:7], 0 idxen offen lds
    v_mfma_f32_4x4x4_16b_bf16 v[228:231], v[240:241], v[248:249], 0 cbsz:4 abid:11
    v_mfma_f32_4x4x4_16b_bf16 v[232:235], v[242:243], v[248:249], 0 cbsz:4 abid:11
    v_mfma_f32_4x4x4_16b_bf16 v[236:239], v[244:245], v[248:249], 0 cbsz:4 abid:11
    s_lshr_b32 m0, s53, 16
    ds_read_b32 v252, v105 offset:428
    s_cmp_le_u32 s37, 12
    s_setprio 1
    v_pk_fma_f32 v[40:41], v[130:131], v[228:229], v[40:41] op_sel:[1,0,0] op_sel_hi:[1,1,1] neg_hi:[1,0,0]
    v_pk_fma_f32 v[20:21], v[146:147], v[232:233], v[20:21] op_sel:[1,0,0] op_sel_hi:[1,1,1]
    v_pk_fma_f32 v[0:1], v[162:163], v[236:237], v[0:1] op_sel:[1,0,0] op_sel_hi:[1,1,1]
    v_fmac_f32 v100, v231, v131
    v_fmac_f32 v61, v230, v179
    v_fmac_f32 v81, v234, v147
    v_fmac_f32 v60, v235, v195
    v_fmac_f32 v80, v238, v163
    s_mov_b32 m0, 0
    ds_read_b64_tr_b16 v[248:249], v101 offset:2560
    s_waitcnt lgkmcnt(2) vmcnt(12)
    s_cbranch_scc1 K2_exit
    v_mfma_f32_4x4x4_16b_bf16 v[228:231], v[240:241], v[246:247], 0 cbsz:4 abid:12
    v_mfma_f32_4x4x4_16b_bf16 v[232:235], v[242:243], v[246:247], 0 cbsz:4 abid:12
    v_mfma_f32_4x4x4_16b_bf16 v[236:239], v[244:245], v[246:247], 0 cbsz:4 abid:12
    s_mov_b32 m0, s54
    ds_read_b128 v[188:191], v111 offset:0
    ds_read_b128 v[192:195], v111 offset:1024
    v_pk_fma_f32 v[40:41], v[132:133], v[228:229], v[40:41] op_sel:[0,0,0] op_sel_hi:[0,1,1] neg_hi:[1,0,0]
    v_pk_fma_f32 v[20:21], v[148:149], v[232:233], v[20:21] op_sel:[0,0,0] op_sel_hi:[0,1,1]
    v_pk_fma_f32 v[0:1], v[164:165], v[236:237], v[0:1] op_sel:[0,0,0] op_sel_hi:[0,1,1]
    v_fmac_f32 v100, v231, v132
    v_fmac_f32 v61, v230, v180
    v_fmac_f32 v81, v234, v148
    v_fmac_f32 v60, v235, v196
    v_fmac_f32 v80, v238, v164
    s_add_u32 m0, s86, 2048
    ds_read_b64_tr_b16 v[246:247], v101 offset:3072
    s_waitcnt lgkmcnt(3)
    buffer_load_dwordx4 v[252:253], s[4:7], 0 idxen offen lds
    v_mfma_f32_4x4x4_16b_bf16 v[228:231], v[240:241], v[248:249], 0 cbsz:4 abid:13
    v_mfma_f32_4x4x4_16b_bf16 v[232:235], v[242:243], v[248:249], 0 cbsz:4 abid:13
    v_mfma_f32_4x4x4_16b_bf16 v[236:239], v[244:245], v[248:249], 0 cbsz:4 abid:13
    s_lshr_b32 m0, s54, 16
    ds_read_b32 v252, v105 offset:460
    ds_read_b128 v[128:131], v119
    v_pk_fma_f32 v[40:41], v[132:133], v[228:229], v[40:41] op_sel:[1,0,0] op_sel_hi:[1,1,1] neg_hi:[1,0,0]
    v_pk_fma_f32 v[20:21], v[148:149], v[232:233], v[20:21] op_sel:[1,0,0] op_sel_hi:[1,1,1]
    v_pk_fma_f32 v[0:1], v[164:165], v[236:237], v[0:1] op_sel:[1,0,0] op_sel_hi:[1,1,1]
    v_fmac_f32 v100, v231, v133
    v_fmac_f32 v61, v230, v181
    v_fmac_f32 v81, v234, v149
    v_fmac_f32 v60, v235, v197
    v_fmac_f32 v80, v238, v165
    s_mov_b32 m0, 0
    ds_read_b64_tr_b16 v[248:249], v101 offset:3584
    s_waitcnt lgkmcnt(3) vmcnt(12)
    v_add_u32 v101, s88, v101
    v_mfma_f32_4x4x4_16b_bf16 v[228:231], v[240:241], v[246:247], 0 cbsz:4 abid:14
    v_mfma_f32_4x4x4_16b_bf16 v[232:235], v[242:243], v[246:247], 0 cbsz:4 abid:14
    v_mfma_f32_4x4x4_16b_bf16 v[236:239], v[244:245], v[246:247], 0 cbsz:4 abid:14
    s_mov_b32 m0, s55
    ds_read_b128 v[144:147], v119
    ds_read_b128 v[160:163], v119
    v_pk_fma_f32 v[40:41], v[134:135], v[228:229], v[40:41] op_sel:[0,0,0] op_sel_hi:[0,1,1] neg_hi:[1,0,0]
    v_pk_fma_f32 v[20:21], v[150:151], v[232:233], v[20:21] op_sel:[0,0,0] op_sel_hi:[0,1,1]
    v_pk_fma_f32 v[0:1], v[166:167], v[236:237], v[0:1] op_sel:[0,0,0] op_sel_hi:[0,1,1]
    v_fmac_f32 v100, v231, v134
    v_fmac_f32 v61, v230, v182
    v_fmac_f32 v81, v234, v150
    v_fmac_f32 v60, v235, v198
    v_fmac_f32 v80, v238, v166
    s_add_u32 m0, s86, 3072
    ds_read_b64_tr_b16 v[246:247], v101 offset:0
    s_waitcnt lgkmcnt(3)
    buffer_load_dwordx4 v[252:253], s[4:7], 0 idxen offen lds
    v_mfma_f32_4x4x4_16b_bf16 v[228:231], v[240:241], v[248:249], 0 cbsz:4 abid:15
    v_mfma_f32_4x4x4_16b_bf16 v[232:235], v[242:243], v[248:249], 0 cbsz:4 abid:15
    v_mfma_f32_4x4x4_16b_bf16 v[236:239], v[244:245], v[248:249], 0 cbsz:4 abid:15
    s_lshr_b32 m0, s55, 16
    ds_read_b32 v252, v105 offset:492
    ds_read_b128 v[176:179], v119
    v_pk_fma_f32 v[40:41], v[134:135], v[228:229], v[40:41] op_sel:[1,0,0] op_sel_hi:[1,1,1] neg_hi:[1,0,0]
    v_pk_fma_f32 v[20:21], v[150:151], v[232:233], v[20:21] op_sel:[1,0,0] op_sel_hi:[1,1,1]
    v_pk_fma_f32 v[0:1], v[166:167], v[236:237], v[0:1] op_sel:[1,0,0] op_sel_hi:[1,1,1]
    v_fmac_f32 v100, v231, v135
    v_fmac_f32 v61, v230, v183
    v_fmac_f32 v81, v234, v151
    v_fmac_f32 v60, v235, v199
    v_fmac_f32 v80, v238, v167
    s_mov_b32 m0, 0
    s_sub_u32 s37, s37, 16
    s_cmp_gt_i32 s37, 0
    s_cbranch_scc1 K2_tile
K2_exit:
    s_set_gpr_idx_off
K2_done:
    s_cmp_lt_u32 s45, 7
    s_cbranch_scc1 K2_nextsub
    s_cmp_eq_u32 s43, 0
    s_cbranch_scc1 K2_epi
    s_mov_b32 s45, 8
    s_add_u32 s44, s44, 1
    s_cmp_ge_u32 s44, 79
    s_cbranch_scc1 K2_epi
    s_branch K2_again
K2_nextsub:
    s_add_u32 s45, s45, 1
    s_branch K2_again
K2_toscan:
    s_mov_b32 s43, 1
    s_branch K2_again
K2_tosub:
    s_mov_b32 s45, 0
K2_again:
    s_waitcnt vmcnt(0) lgkmcnt(0)
    s_branch K2_batch
K2_epi:
    s_waitcnt vmcnt(0) lgkmcnt(0)
    v_mbcnt_lo_u32_b32 v200, -1, 0
    v_mbcnt_hi_u32_b32 v200, -1, v200
    v_lshlrev_b32 v239, 4, v200
    s_and_b32 s59, s33, 3
    s_mul_i32 s58, s59, 40960
    s_add_u32 s58, s58, 2097152
    s_lshl_b32 s46, s34, 4
    s_add_u32 s46, s46, s39
    v_lshl_add_u32 v202, v200, 2, s46
    v_and_b32 v204, 1, v200
    v_sub_u32 v205, v200, v204
    v_lshl_add_u32 v205, v205, 1, s46
    v_lshl_add_u32 v203, v204, 7, v205
    v_mul_u32_u24 v206, 1472, v204
    v_add_u32 v205, v206, v205
    v_sub_u32 v204, 0, v204
    v_and_b32 v204, 0x06060606, v204
    v_xor_b32 v204, 0x05040100, v204
    s_cmp_lt_u32 s33, 4
    s_cbranch_scc1 K2_gemm
    s_add_u32 s58, s58, 16384
    buffer_load_dwordx4 v[120:123], v239, s[20:23], s58 offen offset:0
    buffer_load_dwordx4 v[124:127], v239, s[20:23], s58 offen offset:1024
    v_cvt_pk_bf16_f32 v212, v40, v41
    v_cvt_pk_bf16_f32 v213, v100, v102
    v_cvt_pk_bf16_f32 v208, v60, v61
    v_cvt_pk_bf16_f32 v209, v20, v0
    v_mov_b32_dpp v206, v212 quad_perm:[1,0,3,2] row_mask:0xf bank_mask:0xf
    ds_write2_b32 v202, v208, v209 offset1:64
    v_cvt_pk_bf16_f32 v210, v21, v1
    v_cvt_pk_bf16_f32 v211, v81, v80
    v_perm_b32 v212, v206, v212, v204
    ds_write2_b32 v202, v210, v211 offset0:128 offset1:192
    ds_write_b32 v203, v212 offset:1024
    v_mov_b32_dpp v207, v213 quad_perm:[1,0,3,2] row_mask:0xf bank_mask:0xf
    v_perm_b32 v213, v207, v213, v204
    ds_write_b32 v205, v213 offset:1280
    v_add_u32 v202, 1472, v202
    buffer_load_dwordx4 v[128:131], v239, s[20:23], s58 offen offset:2048
    buffer_load_dwordx4 v[132:135], v239, s[20:23], s58 offen offset:3072
    s_add_u32 s58, s58, 4096
    v_cvt_pk_bf16_f32 v218, v42, v43
    v_cvt_pk_bf16_f32 v214, v62, v63
    v_cvt_pk_bf16_f32 v215, v22, v2
    v_mov_b32_dpp v206, v218 quad_perm:[1,0,3,2] row_mask:0xf bank_mask:0xf
    ds_write2_b32 v202, v214, v215 offset1:64
    v_cvt_pk_bf16_f32 v216, v23, v3
    v_cvt_pk_bf16_f32 v217, v83, v82
    v_perm_b32 v218, v206, v218, v204
    ds_write2_b32 v202, v216, v217 offset0:128 offset1:192
    ds_write_b32 v203, v218 offset:2496
    v_add_u32 v202, 1472, v202
    buffer_load_dwordx4 v[136:139], v239, s[20:23], s58 offen offset:0
    buffer_load_dwordx4 v[140:143], v239, s[20:23], s58 offen offset:1024
    v_cvt_pk_bf16_f32 v224, v44, v45
    v_cvt_pk_bf16_f32 v225, v104, v106
    v_cvt_pk_bf16_f32 v220, v64, v65
    v_cvt_pk_bf16_f32 v221, v24, v4
    v_mov_b32_dpp v206, v224 quad_perm:[1,0,3,2] row_mask:0xf bank_mask:0xf
    ds_write2_b32 v202, v220, v221 offset1:64
    v_cvt_pk_bf16_f32 v222, v25, v5
    v_cvt_pk_bf16_f32 v223, v85, v84
    v_perm_b32 v224, v206, v224, v204
    ds_write2_b32 v202, v222, v223 offset0:128 offset1:192
    ds_write_b32 v203, v224 offset:3968
    v_mov_b32_dpp v207, v225 quad_perm:[1,0,3,2] row_mask:0xf bank_mask:0xf
    v_perm_b32 v225, v207, v225, v204
    ds_write_b32 v205, v225 offset:4224
    v_add_u32 v202, 1472, v202
    buffer_load_dwordx4 v[144:147], v239, s[20:23], s58 offen offset:2048
    buffer_load_dwordx4 v[148:151], v239, s[20:23], s58 offen offset:3072
    s_add_u32 s58, s58, 4096
    v_cvt_pk_bf16_f32 v230, v46, v47
    v_cvt_pk_bf16_f32 v226, v66, v67
    v_cvt_pk_bf16_f32 v227, v26, v6
    v_mov_b32_dpp v206, v230 quad_perm:[1,0,3,2] row_mask:0xf bank_mask:0xf
    ds_write2_b32 v202, v226, v227 offset1:64
    v_cvt_pk_bf16_f32 v228, v27, v7
    v_cvt_pk_bf16_f32 v229, v87, v86
    v_perm_b32 v230, v206, v230, v204
    ds_write2_b32 v202, v228, v229 offset0:128 offset1:192
    ds_write_b32 v203, v230 offset:5440
    v_add_u32 v202, 1472, v202
    buffer_load_dwordx4 v[152:155], v239, s[20:23], s58 offen offset:0
    buffer_load_dwordx4 v[156:159], v239, s[20:23], s58 offen offset:1024
    v_cvt_pk_bf16_f32 v212, v48, v49
    v_cvt_pk_bf16_f32 v213, v108, v110
    v_cvt_pk_bf16_f32 v208, v68, v69
    v_cvt_pk_bf16_f32 v209, v28, v8
    v_mov_b32_dpp v206, v212 quad_perm:[1,0,3,2] row_mask:0xf bank_mask:0xf
    ds_write2_b32 v202, v208, v209 offset1:64
    v_cvt_pk_bf16_f32 v210, v29, v9
    v_cvt_pk_bf16_f32 v211, v89, v88
    v_perm_b32 v212, v206, v212, v204
    ds_write2_b32 v202, v210, v211 offset0:128 offset1:192
    ds_write_b32 v203, v212 offset:6912
    v_mov_b32_dpp v207, v213 quad_perm:[1,0,3,2] row_mask:0xf bank_mask:0xf
    v_perm_b32 v213, v207, v213, v204
    ds_write_b32 v205, v213 offset:7168
    v_add_u32 v202, 1472, v202
    buffer_load_dwordx4 v[160:163], v239, s[20:23], s58 offen offset:2048
    buffer_load_dwordx4 v[164:167], v239, s[20:23], s58 offen offset:3072
    s_add_u32 s58, s58, 4096
    v_cvt_pk_bf16_f32 v218, v50, v51
    v_cvt_pk_bf16_f32 v214, v70, v71
    v_cvt_pk_bf16_f32 v215, v30, v10
    v_mov_b32_dpp v206, v218 quad_perm:[1,0,3,2] row_mask:0xf bank_mask:0xf
    ds_write2_b32 v202, v214, v215 offset1:64
    v_cvt_pk_bf16_f32 v216, v31, v11
    v_cvt_pk_bf16_f32 v217, v91, v90
    v_perm_b32 v218, v206, v218, v204
    ds_write2_b32 v202, v216, v217 offset0:128 offset1:192
    ds_write_b32 v203, v218 offset:8384
    v_add_u32 v202, 1472, v202
    buffer_load_dwordx4 v[168:171], v239, s[20:23], s58 offen offset:0
    buffer_load_dwordx4 v[172:175], v239, s[20:23], s58 offen offset:1024
    v_cvt_pk_bf16_f32 v224, v52, v53
    v_cvt_pk_bf16_f32 v225, v112, v114
    v_cvt_pk_bf16_f32 v220, v72, v73
    v_cvt_pk_bf16_f32 v221, v32, v12
    v_mov_b32_dpp v206, v224 quad_perm:[1,0,3,2] row_mask:0xf bank_mask:0xf
    ds_write2_b32 v202, v220, v221 offset1:64
    v_cvt_pk_bf16_f32 v222, v33, v13
    v_cvt_pk_bf16_f32 v223, v93, v92
    v_perm_b32 v224, v206, v224, v204
    ds_write2_b32 v202, v222, v223 offset0:128 offset1:192
    ds_write_b32 v203, v224 offset:9856
    v_mov_b32_dpp v207, v225 quad_perm:[1,0,3,2] row_mask:0xf bank_mask:0xf
    v_perm_b32 v225, v207, v225, v204
    ds_write_b32 v205, v225 offset:10112
    v_add_u32 v202, 1472, v202
    buffer_load_dwordx4 v[176:179], v239, s[20:23], s58 offen offset:2048
    buffer_load_dwordx4 v[180:183], v239, s[20:23], s58 offen offset:3072
    s_add_u32 s58, s58, 4096
    v_cvt_pk_bf16_f32 v230, v54, v55
    v_cvt_pk_bf16_f32 v226, v74, v75
    v_cvt_pk_bf16_f32 v227, v34, v14
    v_mov_b32_dpp v206, v230 quad_perm:[1,0,3,2] row_mask:0xf bank_mask:0xf
    ds_write2_b32 v202, v226, v227 offset1:64
    v_cvt_pk_bf16_f32 v228, v35, v15
    v_cvt_pk_bf16_f32 v229, v95, v94
    v_perm_b32 v230, v206, v230, v204
    ds_write2_b32 v202, v228, v229 offset0:128 offset1:192
    ds_write_b32 v203, v230 offset:11328
    v_add_u32 v202, 1472, v202
    buffer_load_dwordx4 v[184:187], v239, s[20:23], s58 offen offset:0
    buffer_load_dwordx4 v[188:191], v239, s[20:23], s58 offen offset:1024
    v_cvt_pk_bf16_f32 v212, v56, v57
    v_cvt_pk_bf16_f32 v213, v116, v118
    v_cvt_pk_bf16_f32 v208, v76, v77
    v_cvt_pk_bf16_f32 v209, v36, v16
    v_mov_b32_dpp v206, v212 quad_perm:[1,0,3,2] row_mask:0xf bank_mask:0xf
    ds_write2_b32 v202, v208, v209 offset1:64
    v_cvt_pk_bf16_f32 v210, v37, v17
    v_cvt_pk_bf16_f32 v211, v97, v96
    v_perm_b32 v212, v206, v212, v204
    ds_write2_b32 v202, v210, v211 offset0:128 offset1:192
    ds_write_b32 v203, v212 offset:12800
    v_mov_b32_dpp v207, v213 quad_perm:[1,0,3,2] row_mask:0xf bank_mask:0xf
    v_perm_b32 v213, v207, v213, v204
    ds_write_b32 v205, v213 offset:13056
    v_add_u32 v202, 1472, v202
    buffer_load_dwordx4 v[192:195], v239, s[20:23], s58 offen offset:2048
    buffer_load_dwordx4 v[196:199], v239, s[20:23], s58 offen offset:3072
    s_add_u32 s58, s58, 4096
    v_cvt_pk_bf16_f32 v218, v58, v59
    v_cvt_pk_bf16_f32 v214, v78, v79
    v_cvt_pk_bf16_f32 v215, v38, v18
    v_mov_b32_dpp v206, v218 quad_perm:[1,0,3,2] row_mask:0xf bank_mask:0xf
    ds_write2_b32 v202, v214, v215 offset1:64
    v_cvt_pk_bf16_f32 v216, v39, v19
    v_cvt_pk_bf16_f32 v217, v99, v98
    v_perm_b32 v218, v206, v218, v204
    ds_write2_b32 v202, v216, v217 offset0:128 offset1:192
    ds_write_b32 v203, v218 offset:14272
    v_and_b32 v0, 3, v200
    v_mul_u32_u24 v0, 29712, v0
    v_lshrrev_b32 v1, 5, v200
    v_lshl_add_u32 v0, v1, 4, v0
    v_bfe_u32 v2, v200, 2, 3
    v_mul_u32_u24 v3, 1472, v2
    v_add_u32 v232, v0, v3
    v_and_b32 v3, 1, v2
    v_add_u32 v3, 8, v3
    v_mul_u32_u24 v3, 1472, v3
    v_add_u32 v233, v0, v3
    v_lshrrev_b32 v4, 1, v2
    v_min_u32 v5, 2, v4
    v_lshl_add_u32 v234, v5, 8, v233
    v_lshl_add_u32 v235, v5, 7, v233
    v_and_b32 v3, 31, v200
    v_lshlrev_b32 v3, 2, v3
    v_add_u32 v6, 151680, v3
    v_and_b32 v3, 28, v3
    v_add_u32 v7, 151808, v3
    ds_read_b32 v6, v6
    ds_read_b32 v7, v7
    s_lshl_b32 s3, s92, 10
    s_lshl_b32 s46, s59, 6
    s_add_u32 s3, s3, s46
    s_add_u32 s18, s92, s93
    s_lshl_b32 s18, s18, 10
    v_lshlrev_b32 v1, 5, v1
    v_min_u32 v8, 1, v4
    v_sub_u32 v9, v4, v5
    s_waitcnt lgkmcnt(0)
    v_lshl_add_u32 v236, v6, 10, v1
    v_lshl_add_u32 v7, v7, 10, v1
    v_lshl_add_u32 v237, v8, 31, v7
    v_lshl_add_u32 v7, v5, 8, v7
    v_lshl_add_u32 v238, v9, 31, v7
    s_lshl_b32 s46, s59, 13
    s_add_u32 s46, s46, 118784
    v_add_u32 v96, s46, v239
    s_barrier
    s_setprio 0
    v_lshrrev_b32 v0, 4, v239
    v_and_b32 v1, 0x3c, v0
    v_add_u32 v2, 64, v1
    ds_bpermute_b32 v116, v1, v236
    ds_bpermute_b32 v117, v2, v236
    ds_bpermute_b32 v118, v1, v238
    ds_bpermute_b32 v119, v2, v238
    s_mul_i32 s46, s59, 2560
    s_add_u32 s46, s46, 151936
    v_and_b32 v3, 48, v239
    v_mul_u32_u24 v1, 20, v1
    v_add3_u32 v98, v1, v3, s46
    v_and_b32 v1, 31, v0
    v_mul_u32_u24 v1, 80, v1
    v_and_b32 v2, 32, v0
    v_add3_u32 v97, v1, v2, s46
    s_waitcnt lgkmcnt(0)
    v_add_u32 v116, v116, v3
    v_add_u32 v117, v117, v3
    v_add_u32 v118, v118, v3
    v_add_u32 v119, v119, v3
    buffer_load_dwordx4 v[100:103], v239, s[20:23], s58 offen offset:0
    buffer_load_dwordx4 v[104:107], v239, s[20:23], s58 offen offset:1024
    buffer_load_dwordx4 v[108:111], v239, s[20:23], s58 offen offset:2048
    buffer_load_dwordx4 v[112:115], v239, s[20:23], s58 offen offset:3072
    s_add_u32 s58, s58, 4096
    ds_read_b128 v[200:203], v232 offset:256
    ds_read_b128 v[204:207], v232 offset:288
    ds_read_b128 v[208:211], v232 offset:320
    ds_read_b128 v[212:215], v232 offset:352
    ds_read_b128 v[216:219], v232 offset:384
    ds_read_b128 v[220:223], v232 offset:416
    ds_read_b128 v[224:227], v232 offset:448
    s_waitcnt lgkmcnt(5) vmcnt(22)
    v_mfma_f32_32x32x16_bf16 v[0:15], v[120:123], v[200:203], 0
    ds_read_b128 v[228:231], v232 offset:480
    v_mfma_f32_32x32x16_bf16 v[0:15], v[124:127], v[204:207], v[0:15]
    ds_read_b128 v[200:203], v232 offset:1024
    s_waitcnt lgkmcnt(5) vmcnt(20)
    v_mfma_f32_32x32x16_bf16 v[0:15], v[128:131], v[208:211], v[0:15]
    ds_read_b128 v[204:207], v232 offset:1056
    v_mfma_f32_32x32x16_bf16 v[0:15], v[132:135], v[212:215], v[0:15]
    ds_read_b128 v[208:211], v232 offset:1088
    s_waitcnt lgkmcnt(5) vmcnt(18)
    v_mfma_f32_32x32x16_bf16 v[0:15], v[136:139], v[216:219], v[0:15]
    ds_read_b128 v[212:215], v232 offset:1120
    v_mfma_f32_32x32x16_bf16 v[0:15], v[140:143], v[220:223], v[0:15]
    ds_read_b128 v[216:219], v232 offset:15104
    s_waitcnt lgkmcnt(5) vmcnt(16)
    v_mfma_f32_32x32x16_bf16 v[0:15], v[144:147], v[224:227], v[0:15]
    ds_read_b128 v[220:223], v232 offset:15136
    v_mfma_f32_32x32x16_bf16 v[0:15], v[148:151], v[228:231], v[0:15]
    ds_read_b128 v[224:227], v232 offset:15168
    s_waitcnt lgkmcnt(5) vmcnt(14)
    v_mfma_f32_32x32x16_bf16 v[0:15], v[152:155], v[200:203], v[0:15]
    ds_read_b128 v[228:231], v232 offset:15200
    v_mfma_f32_32x32x16_bf16 v[0:15], v[156:159], v[204:207], v[0:15]
    ds_read_b128 v[200:203], v232 offset:15232
    s_waitcnt lgkmcnt(5) vmcnt(12)
    v_mfma_f32_32x32x16_bf16 v[0:15], v[160:163], v[208:211], v[0:15]
    ds_read_b128 v[204:207], v232 offset:15264
    v_mfma_f32_32x32x16_bf16 v[0:15], v[164:167], v[212:215], v[0:15]
    ds_read_b128 v[208:211], v232 offset:15296
    s_waitcnt lgkmcnt(5) vmcnt(10)
    v_mfma_f32_32x32x16_bf16 v[0:15], v[168:171], v[216:219], v[0:15]
    ds_read_b128 v[212:215], v232 offset:15328
    v_mfma_f32_32x32x16_bf16 v[0:15], v[172:175], v[220:223], v[0:15]
    ds_read_b128 v[216:219], v232 offset:15872
    s_waitcnt lgkmcnt(5) vmcnt(8)
    v_mfma_f32_32x32x16_bf16 v[0:15], v[176:179], v[224:227], v[0:15]
    ds_read_b128 v[220:223], v232 offset:15904
    v_mfma_f32_32x32x16_bf16 v[0:15], v[180:183], v[228:231], v[0:15]
    ds_read_b128 v[224:227], v232 offset:15936
    s_waitcnt lgkmcnt(5) vmcnt(6)
    v_mfma_f32_32x32x16_bf16 v[0:15], v[184:187], v[200:203], v[0:15]
    ds_read_b128 v[228:231], v232 offset:15968
    v_mfma_f32_32x32x16_bf16 v[0:15], v[188:191], v[204:207], v[0:15]
    ds_read_b128 v[200:203], v232 offset:512
    s_waitcnt lgkmcnt(5) vmcnt(4)
    v_mfma_f32_32x32x16_bf16 v[0:15], v[192:195], v[208:211], v[0:15]
    ds_read_b128 v[204:207], v232 offset:544
    v_mfma_f32_32x32x16_bf16 v[0:15], v[196:199], v[212:215], v[0:15]
    ds_read_b128 v[208:211], v232 offset:576
    s_waitcnt lgkmcnt(5) vmcnt(2)
    v_mfma_f32_32x32x16_bf16 v[0:15], v[100:103], v[216:219], v[0:15]
    ds_read_b128 v[212:215], v232 offset:608
    v_mfma_f32_32x32x16_bf16 v[0:15], v[104:107], v[220:223], v[0:15]
    ds_read_b128 v[216:219], v232 offset:640
    s_waitcnt lgkmcnt(5) vmcnt(0)
    v_mfma_f32_32x32x16_bf16 v[0:15], v[108:111], v[224:227], v[0:15]
    ds_read_b128 v[220:223], v232 offset:672
    v_mfma_f32_32x32x16_bf16 v[0:15], v[112:115], v[228:231], v[0:15]
    ds_read_b128 v[224:227], v232 offset:704
    s_waitcnt lgkmcnt(5)
    v_mfma_f32_32x32x16_bf16 v[16:31], v[120:123], v[200:203], 0
    ds_read_b128 v[228:231], v232 offset:736
    v_mfma_f32_32x32x16_bf16 v[16:31], v[124:127], v[204:207], v[16:31]
    ds_read_b128 v[200:203], v232 offset:1152
    s_waitcnt lgkmcnt(5)
    v_mfma_f32_32x32x16_bf16 v[16:31], v[128:131], v[208:211], v[16:31]
    ds_read_b128 v[204:207], v232 offset:1184
    v_mfma_f32_32x32x16_bf16 v[16:31], v[132:135], v[212:215], v[16:31]
    ds_read_b128 v[208:211], v232 offset:1216
    s_waitcnt lgkmcnt(5)
    v_mfma_f32_32x32x16_bf16 v[16:31], v[136:139], v[216:219], v[16:31]
    ds_read_b128 v[212:215], v232 offset:1248
    v_mfma_f32_32x32x16_bf16 v[16:31], v[140:143], v[220:223], v[16:31]
    ds_read_b128 v[216:219], v232 offset:15360
    s_waitcnt lgkmcnt(5)
    v_mfma_f32_32x32x16_bf16 v[16:31], v[144:147], v[224:227], v[16:31]
    ds_read_b128 v[220:223], v232 offset:15392
    v_mfma_f32_32x32x16_bf16 v[16:31], v[148:151], v[228:231], v[16:31]
    ds_read_b128 v[224:227], v232 offset:15424
    s_waitcnt lgkmcnt(5)
    v_mfma_f32_32x32x16_bf16 v[16:31], v[152:155], v[200:203], v[16:31]
    ds_read_b128 v[228:231], v232 offset:15456
    v_mfma_f32_32x32x16_bf16 v[16:31], v[156:159], v[204:207], v[16:31]
    ds_read_b128 v[200:203], v232 offset:15488
    s_waitcnt lgkmcnt(5)
    v_mfma_f32_32x32x16_bf16 v[16:31], v[160:163], v[208:211], v[16:31]
    ds_read_b128 v[204:207], v232 offset:15520
    v_mfma_f32_32x32x16_bf16 v[16:31], v[164:167], v[212:215], v[16:31]
    ds_read_b128 v[208:211], v232 offset:15552
    s_waitcnt lgkmcnt(5)
    v_mfma_f32_32x32x16_bf16 v[16:31], v[168:171], v[216:219], v[16:31]
    ds_read_b128 v[212:215], v232 offset:15584
    v_mfma_f32_32x32x16_bf16 v[16:31], v[172:175], v[220:223], v[16:31]
    ds_read_b128 v[216:219], v232 offset:16000
    s_waitcnt lgkmcnt(5)
    v_mfma_f32_32x32x16_bf16 v[16:31], v[176:179], v[224:227], v[16:31]
    ds_read_b128 v[220:223], v232 offset:16032
    v_mfma_f32_32x32x16_bf16 v[16:31], v[180:183], v[228:231], v[16:31]
    ds_read_b128 v[224:227], v232 offset:16064
    s_waitcnt lgkmcnt(5)
    v_mfma_f32_32x32x16_bf16 v[16:31], v[184:187], v[200:203], v[16:31]
    ds_read_b128 v[228:231], v232 offset:16096
    v_mfma_f32_32x32x16_bf16 v[16:31], v[188:191], v[204:207], v[16:31]
    ds_read_b128 v[200:203], v232 offset:768
    s_waitcnt lgkmcnt(5)
    v_mfma_f32_32x32x16_bf16 v[16:31], v[192:195], v[208:211], v[16:31]
    ds_read_b128 v[204:207], v232 offset:800
    v_mfma_f32_32x32x16_bf16 v[16:31], v[196:199], v[212:215], v[16:31]
    ds_read_b128 v[208:211], v232 offset:832
    s_waitcnt lgkmcnt(5)
    v_mfma_f32_32x32x16_bf16 v[16:31], v[100:103], v[216:219], v[16:31]
    ds_read_b128 v[212:215], v232 offset:864
    v_mfma_f32_32x32x16_bf16 v[16:31], v[104:107], v[220:223], v[16:31]
    ds_read_b128 v[216:219], v232 offset:896
    s_waitcnt lgkmcnt(5)
    v_mfma_f32_32x32x16_bf16 v[16:31], v[108:111], v[224:227], v[16:31]
    s_barrier
    ds_read_b128 v[64:67], v96 offset:0
    ds_read_b128 v[68:71], v96 offset:1024
    ds_read_b128 v[220:223], v232 offset:928
    v_mfma_f32_32x32x16_bf16 v[16:31], v[112:115], v[228:231], v[16:31]
    ds_read_b128 v[72:75], v96 offset:2048
    ds_read_b128 v[76:79], v96 offset:3072
    ds_read_b128 v[80:83], v96 offset:4096
    ds_read_b128 v[224:227], v232 offset:960
    s_waitcnt lgkmcnt(5)
    v_mfma_f32_32x32x16_bf16 v[32:47], v[120:123], v[200:203], 0
    ds_read_b128 v[84:87], v96 offset:5120
    ds_read_b128 v[88:91], v96 offset:6144
    ds_read_b128 v[92:95], v96 offset:7168
    ds_read_b128 v[228:231], v232 offset:992
    v_mfma_f32_32x32x16_bf16 v[32:47], v[124:127], v[204:207], v[32:47]
    ds_read_b128 v[200:203], v232 offset:1280
    s_waitcnt lgkmcnt(5)
    v_mfma_f32_32x32x16_bf16 v[32:47], v[128:131], v[208:211], v[32:47]
    ds_read_b128 v[204:207], v232 offset:1312
    v_mfma_f32_32x32x16_bf16 v[32:47], v[132:135], v[212:215], v[32:47]
    ds_read_b128 v[208:211], v232 offset:1344
    s_waitcnt lgkmcnt(5)
    v_mfma_f32_32x32x16_bf16 v[32:47], v[136:139], v[216:219], v[32:47]
    ds_read_b128 v[212:215], v232 offset:1376
    v_mfma_f32_32x32x16_bf16 v[32:47], v[140:143], v[220:223], v[32:47]
    ds_read_b128 v[216:219], v232 offset:15616
    s_waitcnt lgkmcnt(5)
    v_mfma_f32_32x32x16_bf16 v[32:47], v[144:147], v[224:227], v[32:47]
    ds_read_b128 v[220:223], v232 offset:15648
    v_mfma_f32_32x32x16_bf16 v[32:47], v[148:151], v[228:231], v[32:47]
    ds_read_b128 v[224:227], v232 offset:15680
    s_waitcnt lgkmcnt(5)
    v_mfma_f32_32x32x16_bf16 v[32:47], v[152:155], v[200:203], v[32:47]
    v_mul_f32 v0, v0, v64
    v_mul_f32 v1, v1, v65
    v_mul_f32 v2, v2, v66
    ds_read_b128 v[228:231], v232 offset:15712
    v_mfma_f32_32x32x16_bf16 v[32:47], v[156:159], v[204:207], v[32:47]
    v_mul_f32 v3, v3, v67
    v_mul_f32 v4, v4, v68
    v_mul_f32 v5, v5, v69
    ds_read_b128 v[200:203], v232 offset:15744
    s_waitcnt lgkmcnt(5)
    v_mfma_f32_32x32x16_bf16 v[32:47], v[160:163], v[208:211], v[32:47]
    v_mul_f32 v6, v6, v70
    v_mul_f32 v7, v7, v71
    v_cvt_pk_bf16_f32 v240, v0, v1
    ds_read_b128 v[204:207], v232 offset:15776
    v_mfma_f32_32x32x16_bf16 v[32:47], v[164:167], v[212:215], v[32:47]
    v_cvt_pk_bf16_f32 v241, v2, v3
    v_cvt_pk_bf16_f32 v242, v4, v5
    v_cvt_pk_bf16_f32 v243, v6, v7
    ds_read_b128 v[208:211], v232 offset:15808
    s_waitcnt lgkmcnt(5)
    v_mfma_f32_32x32x16_bf16 v[32:47], v[168:171], v[216:219], v[32:47]
    ds_write_b128 v97, v[240:243] offset:0
    v_mul_f32 v8, v8, v72
    v_mul_f32 v9, v9, v73
    ds_read_b128 v[212:215], v232 offset:15840
    v_mfma_f32_32x32x16_bf16 v[32:47], v[172:175], v[220:223], v[32:47]
    v_mul_f32 v10, v10, v74
    v_mul_f32 v11, v11, v75
    v_mul_f32 v12, v12, v76
    ds_read_b128 v[216:219], v232 offset:16128
    s_waitcnt lgkmcnt(5)
    v_mfma_f32_32x32x16_bf16 v[32:47], v[176:179], v[224:227], v[32:47]
    v_mul_f32 v13, v13, v77
    v_mul_f32 v14, v14, v78
    v_mul_f32 v15, v15, v79
    ds_read_b128 v[220:223], v232 offset:16160
    v_mfma_f32_32x32x16_bf16 v[32:47], v[180:183], v[228:231], v[32:47]
    v_cvt_pk_bf16_f32 v244, v8, v9
    v_cvt_pk_bf16_f32 v245, v10, v11
    v_cvt_pk_bf16_f32 v246, v12, v13
    ds_read_b128 v[224:227], v232 offset:16192
    s_waitcnt lgkmcnt(5)
    v_mfma_f32_32x32x16_bf16 v[32:47], v[184:187], v[200:203], v[32:47]
    v_cvt_pk_bf16_f32 v247, v14, v15
    ds_write_b128 v97, v[244:247] offset:16
    ds_read_b128 v[240:243], v98 offset:0
    ds_read_b128 v[228:231], v232 offset:16224
    v_mfma_f32_32x32x16_bf16 v[32:47], v[188:191], v[204:207], v[32:47]
    ds_read_b128 v[244:247], v98 offset:1280
    ds_read_b128 v[200:203], v234 offset:256
    s_waitcnt lgkmcnt(5)
    v_mfma_f32_32x32x16_bf16 v[32:47], v[192:195], v[208:211], v[32:47]
    v_mul_f32 v16, v16, v64
    v_mul_f32 v17, v17, v65
    v_mul_f32 v18, v18, v66
    ds_read_b128 v[204:207], v234 offset:288
    v_mfma_f32_32x32x16_bf16 v[32:47], v[196:199], v[212:215], v[32:47]
    v_mul_f32 v19, v19, v67
    v_mul_f32 v20, v20, v68
    v_mul_f32 v21, v21, v69
    ds_read_b128 v[208:211], v234 offset:320
    s_waitcnt lgkmcnt(5)
    v_mfma_f32_32x32x16_bf16 v[32:47], v[100:103], v[216:219], v[32:47]
    v_mul_f32 v22, v22, v70
    v_mul_f32 v23, v23, v71
    v_cvt_pk_bf16_f32 v248, v16, v17
    ds_read_b128 v[212:215], v234 offset:352
    v_mfma_f32_32x32x16_bf16 v[32:47], v[104:107], v[220:223], v[32:47]
    v_cvt_pk_bf16_f32 v249, v18, v19
    v_cvt_pk_bf16_f32 v250, v20, v21
    v_cvt_pk_bf16_f32 v251, v22, v23
    ds_read_b128 v[216:219], v234 offset:384
    s_waitcnt lgkmcnt(5)
    v_mfma_f32_32x32x16_bf16 v[32:47], v[108:111], v[224:227], v[32:47]
    ds_write_b128 v97, v[248:251] offset:0
    v_mul_f32 v24, v24, v72
    v_mul_f32 v25, v25, v73
    ds_read_b128 v[220:223], v234 offset:416
    v_mfma_f32_32x32x16_bf16 v[32:47], v[112:115], v[228:231], v[32:47]
    v_mul_f32 v26, v26, v74
    v_mul_f32 v27, v27, v75
    v_mul_f32 v28, v28, v76
    ds_read_b128 v[224:227], v234 offset:448
    s_waitcnt lgkmcnt(5)
    v_mfma_f32_32x32x16_bf16 v[48:63], v[120:123], v[200:203], 0
    v_mul_f32 v29, v29, v77
    v_mul_f32 v30, v30, v78
    v_mul_f32 v31, v31, v79
    ds_read_b128 v[228:231], v234 offset:480
    v_mfma_f32_32x32x16_bf16 v[48:63], v[124:127], v[204:207], v[48:63]
    v_cvt_pk_bf16_f32 v252, v24, v25
    v_cvt_pk_bf16_f32 v253, v26, v27
    v_cvt_pk_bf16_f32 v254, v28, v29
    ds_read_b128 v[200:203], v235 offset:1024
    s_waitcnt lgkmcnt(5)
    v_mfma_f32_32x32x16_bf16 v[48:63], v[128:131], v[208:211], v[48:63]
    v_cvt_pk_bf16_f32 v255, v30, v31
    ds_write_b128 v97, v[252:255] offset:16
    ds_read_b128 v[248:251], v98 offset:0
    ds_read_b128 v[204:207], v235 offset:1056
    v_mfma_f32_32x32x16_bf16 v[48:63], v[132:135], v[212:215], v[48:63]
    ds_read_b128 v[252:255], v98 offset:1280
    buffer_store_dwordx4 v[240:243], v116, s[16:19], s3 offen offset:256
    buffer_store_dwordx4 v[244:247], v117, s[16:19], s3 offen offset:256
    ds_read_b128 v[208:211], v235 offset:1088
    s_waitcnt lgkmcnt(5)
    v_mfma_f32_32x32x16_bf16 v[48:63], v[136:139], v[216:219], v[48:63]
    ds_read_b128 v[212:215], v235 offset:1120
    v_mfma_f32_32x32x16_bf16 v[48:63], v[140:143], v[220:223], v[48:63]
    v_mul_f32 v32, v32, v64
    v_mul_f32 v33, v33, v65
    v_mul_f32 v34, v34, v66
    ds_read_b128 v[216:219], v234 offset:15104
    s_waitcnt lgkmcnt(5)
    v_mfma_f32_32x32x16_bf16 v[48:63], v[144:147], v[224:227], v[48:63]
    v_mul_f32 v35, v35, v67
    v_mul_f32 v36, v36, v68
    v_mul_f32 v37, v37, v69
    ds_read_b128 v[220:223], v234 offset:15136
    v_mfma_f32_32x32x16_bf16 v[48:63], v[148:151], v[228:231], v[48:63]
    v_mul_f32 v38, v38, v70
    v_mul_f32 v39, v39, v71
    v_cvt_pk_bf16_f32 v240, v32, v33
    ds_read_b128 v[224:227], v234 offset:15168
    s_waitcnt lgkmcnt(5)
    v_mfma_f32_32x32x16_bf16 v[48:63], v[152:155], v[200:203], v[48:63]
    v_cvt_pk_bf16_f32 v241, v34, v35
    v_cvt_pk_bf16_f32 v242, v36, v37
    v_cvt_pk_bf16_f32 v243, v38, v39
    ds_read_b128 v[228:231], v234 offset:15200
    v_mfma_f32_32x32x16_bf16 v[48:63], v[156:159], v[204:207], v[48:63]
    ds_write_b128 v97, v[240:243] offset:0
    v_mul_f32 v40, v40, v72
    v_mul_f32 v41, v41, v73
    ds_read_b128 v[200:203], v234 offset:15232
    s_waitcnt lgkmcnt(5)
    v_mfma_f32_32x32x16_bf16 v[48:63], v[160:163], v[208:211], v[48:63]
    v_mul_f32 v42, v42, v74
    v_mul_f32 v43, v43, v75
    v_mul_f32 v44, v44, v76
    ds_read_b128 v[204:207], v234 offset:15264
    v_mfma_f32_32x32x16_bf16 v[48:63], v[164:167], v[212:215], v[48:63]
    v_mul_f32 v45, v45, v77
    v_mul_f32 v46, v46, v78
    v_mul_f32 v47, v47, v79
    ds_read_b128 v[208:211], v234 offset:15296
    s_waitcnt lgkmcnt(5)
    v_mfma_f32_32x32x16_bf16 v[48:63], v[168:171], v[216:219], v[48:63]
    v_cvt_pk_bf16_f32 v244, v40, v41
    v_cvt_pk_bf16_f32 v245, v42, v43
    v_cvt_pk_bf16_f32 v246, v44, v45
    ds_read_b128 v[212:215], v234 offset:15328
    v_mfma_f32_32x32x16_bf16 v[48:63], v[172:175], v[220:223], v[48:63]
    v_cvt_pk_bf16_f32 v247, v46, v47
    ds_write_b128 v97, v[244:247] offset:16
    ds_read_b128 v[240:243], v98 offset:0
    ds_read_b128 v[216:219], v235 offset:15872
    s_waitcnt lgkmcnt(5)
    v_mfma_f32_32x32x16_bf16 v[48:63], v[176:179], v[224:227], v[48:63]
    ds_read_b128 v[244:247], v98 offset:1280
    buffer_store_dwordx4 v[248:251], v116, s[16:19], s3 offen offset:512
    buffer_store_dwordx4 v[252:255], v117, s[16:19], s3 offen offset:512
    ds_read_b128 v[220:223], v235 offset:15904
    v_mfma_f32_32x32x16_bf16 v[48:63], v[180:183], v[228:231], v[48:63]
    ds_read_b128 v[224:227], v235 offset:15936
    s_waitcnt lgkmcnt(5)
    v_mfma_f32_32x32x16_bf16 v[48:63], v[184:187], v[200:203], v[48:63]
    ds_read_b128 v[228:231], v235 offset:15968
    v_mfma_f32_32x32x16_bf16 v[48:63], v[188:191], v[204:207], v[48:63]
    s_waitcnt lgkmcnt(4)
    v_mfma_f32_32x32x16_bf16 v[48:63], v[192:195], v[208:211], v[48:63]
    v_mfma_f32_32x32x16_bf16 v[48:63], v[196:199], v[212:215], v[48:63]
    s_waitcnt lgkmcnt(2)
    v_mfma_f32_32x32x16_bf16 v[48:63], v[100:103], v[216:219], v[48:63]
    v_mfma_f32_32x32x16_bf16 v[48:63], v[104:107], v[220:223], v[48:63]
    s_waitcnt lgkmcnt(0)
    v_mfma_f32_32x32x16_bf16 v[48:63], v[108:111], v[224:227], v[48:63]
    v_mfma_f32_32x32x16_bf16 v[48:63], v[112:115], v[228:231], v[48:63]
    buffer_store_dwordx4 v[240:243], v116, s[16:19], s3 offen offset:768
    buffer_store_dwordx4 v[244:247], v117, s[16:19], s3 offen offset:768
    s_nop 11
    v_mul_f32 v48, v48, v80
    v_mul_f32 v49, v49, v81
    v_mul_f32 v50, v50, v82
    v_mul_f32 v51, v51, v83
    v_mul_f32 v52, v52, v84
    v_mul_f32 v53, v53, v85
    v_mul_f32 v54, v54, v86
    v_mul_f32 v55, v55, v87
    v_cvt_pk_bf16_f32 v248, v48, v49
    v_cvt_pk_bf16_f32 v249, v50, v51
    v_cvt_pk_bf16_f32 v250, v52, v53
    v_cvt_pk_bf16_f32 v251, v54, v55
    ds_write_b128 v97, v[248:251] offset:0
    v_mul_f32 v56, v56, v88
    v_mul_f32 v57, v57, v89
    v_mul_f32 v58, v58, v90
    v_mul_f32 v59, v59, v91
    v_mul_f32 v60, v60, v92
    v_mul_f32 v61, v61, v93
    v_mul_f32 v62, v62, v94
    v_mul_f32 v63, v63, v95
    v_cvt_pk_bf16_f32 v252, v56, v57
    v_cvt_pk_bf16_f32 v253, v58, v59
    v_cvt_pk_bf16_f32 v254, v60, v61
    v_cvt_pk_bf16_f32 v255, v62, v63
    ds_write_b128 v97, v[252:255] offset:16
    ds_read_b128 v[248:251], v98 offset:0
    ds_read_b128 v[252:255], v98 offset:1280
    s_waitcnt lgkmcnt(0)
    buffer_store_dwordx4 v[248:251], v118, s[16:19], s3 offen offset:256
    buffer_store_dwordx4 v[252:255], v119, s[16:19], s3 offen offset:256
    s_endpgm
K2_gemm:
    buffer_load_dwordx4 v[120:123], v239, s[20:23], s58 offen offset:0
    buffer_load_dwordx4 v[124:127], v239, s[20:23], s58 offen offset:1024
    v_cvt_pk_bf16_f32 v212, v40, v41
    v_cvt_pk_bf16_f32 v213, v100, v102
    v_cvt_pk_bf16_f32 v208, v60, v61
    v_cvt_pk_bf16_f32 v209, v20, v0
    v_mov_b32_dpp v206, v212 quad_perm:[1,0,3,2] row_mask:0xf bank_mask:0xf
    ds_write2_b32 v202, v208, v209 offset1:64
    v_cvt_pk_bf16_f32 v210, v21, v1
    v_cvt_pk_bf16_f32 v211, v81, v80
    v_perm_b32 v212, v206, v212, v204
    ds_write2_b32 v202, v210, v211 offset0:128 offset1:192
    ds_write_b32 v203, v212 offset:1024
    v_mov_b32_dpp v207, v213 quad_perm:[1,0,3,2] row_mask:0xf bank_mask:0xf
    v_perm_b32 v213, v207, v213, v204
    ds_write_b32 v205, v213 offset:1280
    v_add_u32 v202, 1472, v202
    buffer_load_dwordx4 v[128:131], v239, s[20:23], s58 offen offset:2048
    buffer_load_dwordx4 v[132:135], v239, s[20:23], s58 offen offset:3072
    s_add_u32 s58, s58, 4096
    v_cvt_pk_bf16_f32 v218, v42, v43
    v_cvt_pk_bf16_f32 v214, v62, v63
    v_cvt_pk_bf16_f32 v215, v22, v2
    v_mov_b32_dpp v206, v218 quad_perm:[1,0,3,2] row_mask:0xf bank_mask:0xf
    ds_write2_b32 v202, v214, v215 offset1:64
    v_cvt_pk_bf16_f32 v216, v23, v3
    v_cvt_pk_bf16_f32 v217, v83, v82
    v_perm_b32 v218, v206, v218, v204
    ds_write2_b32 v202, v216, v217 offset0:128 offset1:192
    ds_write_b32 v203, v218 offset:2496
    v_add_u32 v202, 1472, v202
    buffer_load_dwordx4 v[136:139], v239, s[20:23], s58 offen offset:0
    buffer_load_dwordx4 v[140:143], v239, s[20:23], s58 offen offset:1024
    v_cvt_pk_bf16_f32 v224, v44, v45
    v_cvt_pk_bf16_f32 v225, v104, v106
    v_cvt_pk_bf16_f32 v220, v64, v65
    v_cvt_pk_bf16_f32 v221, v24, v4
    v_mov_b32_dpp v206, v224 quad_perm:[1,0,3,2] row_mask:0xf bank_mask:0xf
    ds_write2_b32 v202, v220, v221 offset1:64
    v_cvt_pk_bf16_f32 v222, v25, v5
    v_cvt_pk_bf16_f32 v223, v85, v84
    v_perm_b32 v224, v206, v224, v204
    ds_write2_b32 v202, v222, v223 offset0:128 offset1:192
    ds_write_b32 v203, v224 offset:3968
    v_mov_b32_dpp v207, v225 quad_perm:[1,0,3,2] row_mask:0xf bank_mask:0xf
    v_perm_b32 v225, v207, v225, v204
    ds_write_b32 v205, v225 offset:4224
    v_add_u32 v202, 1472, v202
    buffer_load_dwordx4 v[144:147], v239, s[20:23], s58 offen offset:2048
    buffer_load_dwordx4 v[148:151], v239, s[20:23], s58 offen offset:3072
    s_add_u32 s58, s58, 4096
    v_cvt_pk_bf16_f32 v230, v46, v47
    v_cvt_pk_bf16_f32 v226, v66, v67
    v_cvt_pk_bf16_f32 v227, v26, v6
    v_mov_b32_dpp v206, v230 quad_perm:[1,0,3,2] row_mask:0xf bank_mask:0xf
    ds_write2_b32 v202, v226, v227 offset1:64
    v_cvt_pk_bf16_f32 v228, v27, v7
    v_cvt_pk_bf16_f32 v229, v87, v86
    v_perm_b32 v230, v206, v230, v204
    ds_write2_b32 v202, v228, v229 offset0:128 offset1:192
    ds_write_b32 v203, v230 offset:5440
    v_add_u32 v202, 1472, v202
    buffer_load_dwordx4 v[152:155], v239, s[20:23], s58 offen offset:0
    buffer_load_dwordx4 v[156:159], v239, s[20:23], s58 offen offset:1024
    v_cvt_pk_bf16_f32 v212, v48, v49
    v_cvt_pk_bf16_f32 v213, v108, v110
    v_cvt_pk_bf16_f32 v208, v68, v69
    v_cvt_pk_bf16_f32 v209, v28, v8
    v_mov_b32_dpp v206, v212 quad_perm:[1,0,3,2] row_mask:0xf bank_mask:0xf
    ds_write2_b32 v202, v208, v209 offset1:64
    v_cvt_pk_bf16_f32 v210, v29, v9
    v_cvt_pk_bf16_f32 v211, v89, v88
    v_perm_b32 v212, v206, v212, v204
    ds_write2_b32 v202, v210, v211 offset0:128 offset1:192
    ds_write_b32 v203, v212 offset:6912
    v_mov_b32_dpp v207, v213 quad_perm:[1,0,3,2] row_mask:0xf bank_mask:0xf
    v_perm_b32 v213, v207, v213, v204
    ds_write_b32 v205, v213 offset:7168
    v_add_u32 v202, 1472, v202
    buffer_load_dwordx4 v[160:163], v239, s[20:23], s58 offen offset:2048
    buffer_load_dwordx4 v[164:167], v239, s[20:23], s58 offen offset:3072
    s_add_u32 s58, s58, 4096
    v_cvt_pk_bf16_f32 v218, v50, v51
    v_cvt_pk_bf16_f32 v214, v70, v71
    v_cvt_pk_bf16_f32 v215, v30, v10
    v_mov_b32_dpp v206, v218 quad_perm:[1,0,3,2] row_mask:0xf bank_mask:0xf
    ds_write2_b32 v202, v214, v215 offset1:64
    v_cvt_pk_bf16_f32 v216, v31, v11
    v_cvt_pk_bf16_f32 v217, v91, v90
    v_perm_b32 v218, v206, v218, v204
    ds_write2_b32 v202, v216, v217 offset0:128 offset1:192
    ds_write_b32 v203, v218 offset:8384
    v_add_u32 v202, 1472, v202
    buffer_load_dwordx4 v[168:171], v239, s[20:23], s58 offen offset:0
    buffer_load_dwordx4 v[172:175], v239, s[20:23], s58 offen offset:1024
    v_cvt_pk_bf16_f32 v224, v52, v53
    v_cvt_pk_bf16_f32 v225, v112, v114
    v_cvt_pk_bf16_f32 v220, v72, v73
    v_cvt_pk_bf16_f32 v221, v32, v12
    v_mov_b32_dpp v206, v224 quad_perm:[1,0,3,2] row_mask:0xf bank_mask:0xf
    ds_write2_b32 v202, v220, v221 offset1:64
    v_cvt_pk_bf16_f32 v222, v33, v13
    v_cvt_pk_bf16_f32 v223, v93, v92
    v_perm_b32 v224, v206, v224, v204
    ds_write2_b32 v202, v222, v223 offset0:128 offset1:192
    ds_write_b32 v203, v224 offset:9856
    v_mov_b32_dpp v207, v225 quad_perm:[1,0,3,2] row_mask:0xf bank_mask:0xf
    v_perm_b32 v225, v207, v225, v204
    ds_write_b32 v205, v225 offset:10112
    v_add_u32 v202, 1472, v202
    buffer_load_dwordx4 v[176:179], v239, s[20:23], s58 offen offset:2048
    buffer_load_dwordx4 v[180:183], v239, s[20:23], s58 offen offset:3072
    s_add_u32 s58, s58, 4096
    v_cvt_pk_bf16_f32 v230, v54, v55
    v_cvt_pk_bf16_f32 v226, v74, v75
    v_cvt_pk_bf16_f32 v227, v34, v14
    v_mov_b32_dpp v206, v230 quad_perm:[1,0,3,2] row_mask:0xf bank_mask:0xf
    ds_write2_b32 v202, v226, v227 offset1:64
    v_cvt_pk_bf16_f32 v228, v35, v15
    v_cvt_pk_bf16_f32 v229, v95, v94
    v_perm_b32 v230, v206, v230, v204
    ds_write2_b32 v202, v228, v229 offset0:128 offset1:192
    ds_write_b32 v203, v230 offset:11328
    v_add_u32 v202, 1472, v202
    v_cvt_pk_bf16_f32 v212, v56, v57
    v_cvt_pk_bf16_f32 v213, v116, v118
    v_cvt_pk_bf16_f32 v208, v76, v77
    v_cvt_pk_bf16_f32 v209, v36, v16
    v_mov_b32_dpp v206, v212 quad_perm:[1,0,3,2] row_mask:0xf bank_mask:0xf
    ds_write2_b32 v202, v208, v209 offset1:64
    v_cvt_pk_bf16_f32 v210, v37, v17
    v_cvt_pk_bf16_f32 v211, v97, v96
    v_perm_b32 v212, v206, v212, v204
    ds_write2_b32 v202, v210, v211 offset0:128 offset1:192
    ds_write_b32 v203, v212 offset:12800
    v_mov_b32_dpp v207, v213 quad_perm:[1,0,3,2] row_mask:0xf bank_mask:0xf
    v_perm_b32 v213, v207, v213, v204
    ds_write_b32 v205, v213 offset:13056
    v_add_u32 v202, 1472, v202
    v_cvt_pk_bf16_f32 v218, v58, v59
    v_cvt_pk_bf16_f32 v214, v78, v79
    v_cvt_pk_bf16_f32 v215, v38, v18
    v_mov_b32_dpp v206, v218 quad_perm:[1,0,3,2] row_mask:0xf bank_mask:0xf
    ds_write2_b32 v202, v214, v215 offset1:64
    v_cvt_pk_bf16_f32 v216, v39, v19
    v_cvt_pk_bf16_f32 v217, v99, v98
    v_perm_b32 v218, v206, v218, v204
    ds_write2_b32 v202, v216, v217 offset0:128 offset1:192
    ds_write_b32 v203, v218 offset:14272
    v_and_b32 v0, 3, v200
    v_mul_u32_u24 v0, 29712, v0
    v_lshrrev_b32 v1, 5, v200
    v_lshl_add_u32 v0, v1, 4, v0
    v_bfe_u32 v2, v200, 2, 3
    v_mul_u32_u24 v3, 1472, v2
    v_add_u32 v232, v0, v3
    v_and_b32 v3, 1, v2
    v_add_u32 v3, 8, v3
    v_mul_u32_u24 v3, 1472, v3
    v_add_u32 v233, v0, v3
    v_lshrrev_b32 v4, 1, v2
    v_min_u32 v5, 2, v4
    v_lshl_add_u32 v234, v5, 8, v233
    v_lshl_add_u32 v235, v5, 7, v233
    v_and_b32 v3, 31, v200
    v_lshlrev_b32 v3, 2, v3
    v_add_u32 v6, 151680, v3
    v_and_b32 v3, 28, v3
    v_add_u32 v7, 151808, v3
    ds_read_b32 v6, v6
    ds_read_b32 v7, v7
    s_lshl_b32 s3, s92, 10
    s_lshl_b32 s46, s59, 6
    s_add_u32 s3, s3, s46
    s_add_u32 s18, s92, s93
    s_lshl_b32 s18, s18, 10
    v_lshlrev_b32 v1, 5, v1
    v_min_u32 v8, 1, v4
    v_sub_u32 v9, v4, v5
    s_waitcnt lgkmcnt(0)
    v_lshl_add_u32 v236, v6, 10, v1
    v_lshl_add_u32 v7, v7, 10, v1
    v_lshl_add_u32 v237, v8, 31, v7
    v_lshl_add_u32 v7, v5, 8, v7
    v_lshl_add_u32 v238, v9, 31, v7
    s_lshl_b32 s46, s59, 13
    s_add_u32 s46, s46, 118784
    v_add_u32 v96, s46, v239
    s_barrier
    s_setprio 1
    ds_read_b128 v[200:203], v232 offset:0
    ds_read_b128 v[204:207], v232 offset:32
    ds_read_b128 v[208:211], v232 offset:64
    ds_read_b128 v[212:215], v232 offset:96
    ds_read_b128 v[216:219], v232 offset:128
    ds_read_b128 v[220:223], v232 offset:160
    ds_read_b128 v[224:227], v232 offset:192
    s_waitcnt lgkmcnt(5) vmcnt(14)
    v_mfma_f32_32x32x16_bf16 v[0:15], v[120:123], v[200:203], 0
    ds_read_b128 v[228:231], v232 offset:224
    v_mfma_f32_32x32x16_bf16 v[0:15], v[124:127], v[204:207], v[0:15]
    ds_read_b128 v[200:203], v232 offset:14848
    s_waitcnt lgkmcnt(5) vmcnt(12)
    v_mfma_f32_32x32x16_bf16 v[0:15], v[128:131], v[208:211], v[0:15]
    ds_read_b128 v[204:207], v232 offset:14880
    v_mfma_f32_32x32x16_bf16 v[0:15], v[132:135], v[212:215], v[0:15]
    ds_read_b128 v[208:211], v232 offset:14912
    s_waitcnt lgkmcnt(5) vmcnt(10)
    v_mfma_f32_32x32x16_bf16 v[0:15], v[136:139], v[216:219], v[0:15]
    ds_read_b128 v[212:215], v232 offset:14944
    v_mfma_f32_32x32x16_bf16 v[0:15], v[140:143], v[220:223], v[0:15]
    ds_read_b128 v[216:219], v232 offset:14976
    s_waitcnt lgkmcnt(5) vmcnt(8)
    v_mfma_f32_32x32x16_bf16 v[0:15], v[144:147], v[224:227], v[0:15]
    ds_read_b128 v[220:223], v232 offset:15008
    v_mfma_f32_32x32x16_bf16 v[0:15], v[148:151], v[228:231], v[0:15]
    ds_read_b128 v[224:227], v232 offset:15040
    s_waitcnt lgkmcnt(5) vmcnt(6)
    v_mfma_f32_32x32x16_bf16 v[0:15], v[152:155], v[200:203], v[0:15]
    ds_read_b128 v[228:231], v232 offset:15072
    v_mfma_f32_32x32x16_bf16 v[0:15], v[156:159], v[204:207], v[0:15]
    ds_read_b128 v[200:203], v233 offset:0
    s_waitcnt lgkmcnt(5) vmcnt(4)
    v_mfma_f32_32x32x16_bf16 v[0:15], v[160:163], v[208:211], v[0:15]
    ds_read_b128 v[204:207], v233 offset:32
    v_mfma_f32_32x32x16_bf16 v[0:15], v[164:167], v[212:215], v[0:15]
    ds_read_b128 v[208:211], v233 offset:64
    s_waitcnt lgkmcnt(5) vmcnt(2)
    v_mfma_f32_32x32x16_bf16 v[0:15], v[168:171], v[216:219], v[0:15]
    ds_read_b128 v[212:215], v233 offset:96
    v_mfma_f32_32x32x16_bf16 v[0:15], v[172:175], v[220:223], v[0:15]
    ds_read_b128 v[216:219], v233 offset:128
    s_waitcnt lgkmcnt(5) vmcnt(0)
    v_mfma_f32_32x32x16_bf16 v[0:15], v[176:179], v[224:227], v[0:15]
    ds_read_b128 v[220:223], v233 offset:160
    v_mfma_f32_32x32x16_bf16 v[0:15], v[180:183], v[228:231], v[0:15]
    ds_read_b128 v[224:227], v233 offset:192
    s_waitcnt lgkmcnt(5)
    v_mfma_f32_32x32x16_bf16 v[16:31], v[120:123], v[200:203], 0
    ds_read_b128 v[228:231], v233 offset:224
    v_mfma_f32_32x32x16_bf16 v[16:31], v[124:127], v[204:207], v[16:31]
    ds_read_b128 v[200:203], v233 offset:14848
    s_waitcnt lgkmcnt(5)
    v_mfma_f32_32x32x16_bf16 v[16:31], v[128:131], v[208:211], v[16:31]
    ds_read_b128 v[204:207], v233 offset:14880
    v_mfma_f32_32x32x16_bf16 v[16:31], v[132:135], v[212:215], v[16:31]
    ds_read_b128 v[208:211], v233 offset:14912
    s_waitcnt lgkmcnt(5)
    v_mfma_f32_32x32x16_bf16 v[16:31], v[136:139], v[216:219], v[16:31]
    v_cvt_pk_bf16_f32 v240, v0, v1
    v_cvt_pk_bf16_f32 v241, v2, v3
    v_cvt_pk_bf16_f32 v242, v4, v5
    ds_read_b128 v[212:215], v233 offset:14944
    v_mfma_f32_32x32x16_bf16 v[16:31], v[140:143], v[220:223], v[16:31]
    v_cvt_pk_bf16_f32 v243, v6, v7
    buffer_store_dwordx4 v[240:243], v236, s[16:19], s3 offen offset:0
    v_cvt_pk_bf16_f32 v244, v8, v9
    ds_read_b128 v[216:219], v233 offset:14976
    s_waitcnt lgkmcnt(5)
    v_mfma_f32_32x32x16_bf16 v[16:31], v[144:147], v[224:227], v[16:31]
    v_cvt_pk_bf16_f32 v245, v10, v11
    v_cvt_pk_bf16_f32 v246, v12, v13
    v_cvt_pk_bf16_f32 v247, v14, v15
    ds_read_b128 v[220:223], v233 offset:15008
    v_mfma_f32_32x32x16_bf16 v[16:31], v[148:151], v[228:231], v[16:31]
    buffer_store_dwordx4 v[244:247], v236, s[16:19], s3 offen offset:16
    v_mul_f32 v64, 0xbfb8aa3b, v0
    v_mul_f32 v65, 0xbfb8aa3b, v1
    ds_read_b128 v[224:227], v233 offset:15040
    s_waitcnt lgkmcnt(5)
    v_mfma_f32_32x32x16_bf16 v[16:31], v[152:155], v[200:203], v[16:31]
    v_mul_f32 v66, 0xbfb8aa3b, v2
    v_mul_f32 v67, 0xbfb8aa3b, v3
    v_exp_f32 v64, v64
    ds_read_b128 v[228:231], v233 offset:15072
    v_mfma_f32_32x32x16_bf16 v[16:31], v[156:159], v[204:207], v[16:31]
    v_exp_f32 v65, v65
    v_exp_f32 v66, v66
    s_waitcnt lgkmcnt(4)
    v_mfma_f32_32x32x16_bf16 v[16:31], v[160:163], v[208:211], v[16:31]
    v_exp_f32 v67, v67
    v_add_f32 v64, 1.0, v64
    v_mfma_f32_32x32x16_bf16 v[16:31], v[164:167], v[212:215], v[16:31]
    v_add_f32 v65, 1.0, v65
    v_add_f32 v66, 1.0, v66
    v_add_f32 v67, 1.0, v67
    s_waitcnt lgkmcnt(2)
    v_mfma_f32_32x32x16_bf16 v[16:31], v[168:171], v[216:219], v[16:31]
    v_rcp_f32 v64, v64
    v_rcp_f32 v65, v65
    v_mfma_f32_32x32x16_bf16 v[16:31], v[172:175], v[220:223], v[16:31]
    v_rcp_f32 v66, v66
    v_rcp_f32 v67, v67
    s_waitcnt lgkmcnt(0)
    v_mfma_f32_32x32x16_bf16 v[16:31], v[176:179], v[224:227], v[16:31]
    s_nop 0
    ds_write_b128 v96, v[64:67] offset:0
    v_mul_f32 v68, 0xbfb8aa3b, v4
    v_mul_f32 v69, 0xbfb8aa3b, v5
    v_mfma_f32_32x32x16_bf16 v[16:31], v[180:183], v[228:231], v[16:31]
    v_mul_f32 v70, 0xbfb8aa3b, v6
    v_mul_f32 v71, 0xbfb8aa3b, v7
    v_exp_f32 v68, v68
    v_exp_f32 v69, v69
    v_exp_f32 v70, v70
    v_exp_f32 v71, v71
    v_add_f32 v68, 1.0, v68
    v_add_f32 v69, 1.0, v69
    v_add_f32 v70, 1.0, v70
    v_add_f32 v71, 1.0, v71
    v_rcp_f32 v68, v68
    v_rcp_f32 v69, v69
    v_rcp_f32 v70, v70
    v_rcp_f32 v71, v71
    s_nop 0
    ds_write_b128 v96, v[68:71] offset:1024
    v_mul_f32 v72, 0xbfb8aa3b, v8
    v_mul_f32 v73, 0xbfb8aa3b, v9
    v_mul_f32 v74, 0xbfb8aa3b, v10
    v_mul_f32 v75, 0xbfb8aa3b, v11
    v_exp_f32 v72, v72
    v_exp_f32 v73, v73
    v_exp_f32 v74, v74
    v_exp_f32 v75, v75
    v_add_f32 v72, 1.0, v72
    v_add_f32 v73, 1.0, v73
    v_add_f32 v74, 1.0, v74
    v_add_f32 v75, 1.0, v75
    v_rcp_f32 v72, v72
    v_rcp_f32 v73, v73
    v_rcp_f32 v74, v74
    v_rcp_f32 v75, v75
    s_nop 0
    ds_write_b128 v96, v[72:75] offset:2048
    v_mul_f32 v76, 0xbfb8aa3b, v12
    v_mul_f32 v77, 0xbfb8aa3b, v13
    v_mul_f32 v78, 0xbfb8aa3b, v14
    v_mul_f32 v79, 0xbfb8aa3b, v15
    v_exp_f32 v76, v76
    v_exp_f32 v77, v77
    v_exp_f32 v78, v78
    v_exp_f32 v79, v79
    v_add_f32 v76, 1.0, v76
    v_add_f32 v77, 1.0, v77
    v_add_f32 v78, 1.0, v78
    v_add_f32 v79, 1.0, v79
    v_rcp_f32 v76, v76
    v_rcp_f32 v77, v77
    v_rcp_f32 v78, v78
    v_rcp_f32 v79, v79
    s_nop 0
    ds_write_b128 v96, v[76:79] offset:3072
    v_cvt_pk_bf16_f32 v248, v16, v17
    v_cvt_pk_bf16_f32 v249, v18, v19
    v_cvt_pk_bf16_f32 v250, v20, v21
    v_cvt_pk_bf16_f32 v251, v22, v23
    buffer_store_dwordx4 v[248:251], v237, s[16:19], s3 offen offset:0
    v_cvt_pk_bf16_f32 v252, v24, v25
    v_cvt_pk_bf16_f32 v253, v26, v27
    v_cvt_pk_bf16_f32 v254, v28, v29
    v_cvt_pk_bf16_f32 v255, v30, v31
    buffer_store_dwordx4 v[252:255], v237, s[16:19], s3 offen offset:16
    v_mul_f32 v80, 0xbfb8aa3b, v16
    v_mul_f32 v81, 0xbfb8aa3b, v17
    v_mul_f32 v82, 0xbfb8aa3b, v18
    v_mul_f32 v83, 0xbfb8aa3b, v19
    v_exp_f32 v80, v80
    v_exp_f32 v81, v81
    v_exp_f32 v82, v82
    v_exp_f32 v83, v83
    v_add_f32 v80, 1.0, v80
    v_add_f32 v81, 1.0, v81
    v_add_f32 v82, 1.0, v82
    v_add_f32 v83, 1.0, v83
    v_rcp_f32 v80, v80
    v_rcp_f32 v81, v81
    v_rcp_f32 v82, v82
    v_rcp_f32 v83, v83
    s_nop 0
    ds_write_b128 v96, v[80:83] offset:4096
    v_mul_f32 v84, 0xbfb8aa3b, v20
    v_mul_f32 v85, 0xbfb8aa3b, v21
    v_mul_f32 v86, 0xbfb8aa3b, v22
    v_mul_f32 v87, 0xbfb8aa3b, v23
    v_exp_f32 v84, v84
    v_exp_f32 v85, v85
    v_exp_f32 v86, v86
    v_exp_f32 v87, v87
    v_add_f32 v84, 1.0, v84
    v_add_f32 v85, 1.0, v85
    v_add_f32 v86, 1.0, v86
    v_add_f32 v87, 1.0, v87
    v_rcp_f32 v84, v84
    v_rcp_f32 v85, v85
    v_rcp_f32 v86, v86
    v_rcp_f32 v87, v87
    s_nop 0
    ds_write_b128 v96, v[84:87] offset:5120
    v_mul_f32 v88, 0xbfb8aa3b, v24
    v_mul_f32 v89, 0xbfb8aa3b, v25
    v_mul_f32 v90, 0xbfb8aa3b, v26
    v_mul_f32 v91, 0xbfb8aa3b, v27
    v_exp_f32 v88, v88
    v_exp_f32 v89, v89
    v_exp_f32 v90, v90
    v_exp_f32 v91, v91
    v_add_f32 v88, 1.0, v88
    v_add_f32 v89, 1.0, v89
    v_add_f32 v90, 1.0, v90
    v_add_f32 v91, 1.0, v91
    v_rcp_f32 v88, v88
    v_rcp_f32 v89, v89
    v_rcp_f32 v90, v90
    v_rcp_f32 v91, v91
    s_nop 0
    ds_write_b128 v96, v[88:91] offset:6144
    v_mul_f32 v92, 0xbfb8aa3b, v28
    v_mul_f32 v93, 0xbfb8aa3b, v29
    v_mul_f32 v94, 0xbfb8aa3b, v30
    v_mul_f32 v95, 0xbfb8aa3b, v31
    v_exp_f32 v92, v92
    v_exp_f32 v93, v93
    v_exp_f32 v94, v94
    v_exp_f32 v95, v95
    v_add_f32 v92, 1.0, v92
    v_add_f32 v93, 1.0, v93
    v_add_f32 v94, 1.0, v94
    v_add_f32 v95, 1.0, v95
    v_rcp_f32 v92, v92
    v_rcp_f32 v93, v93
    v_rcp_f32 v94, v94
    v_rcp_f32 v95, v95
    s_nop 0
    ds_write_b128 v96, v[92:95] offset:7168
    s_waitcnt lgkmcnt(0)
    s_barrier
K2_fin:
K2_end:
    s_endpgm
.section .rodata,"a"
.p2align 6
.amdhsa_kernel bin_kernel
  .amdhsa_next_free_vgpr 32
  .amdhsa_next_free_sgpr 40
  .amdhsa_accum_offset 32
  .amdhsa_group_segment_fixed_size 0
  .amdhsa_kernarg_size 96
  .amdhsa_user_sgpr_count 2
  .amdhsa_user_sgpr_kernarg_segment_ptr 1
  .amdhsa_system_sgpr_workgroup_id_x 1
.end_amdhsa_kernel
.p2align 6
.amdhsa_kernel gather_scatter__tensor_product_equiv_equiformer__graph_kernel
  .amdhsa_next_free_vgpr 256
  .amdhsa_next_free_sgpr 96
  .amdhsa_accum_offset 256
  .amdhsa_group_segment_fixed_size 0
  .amdhsa_kernarg_size 96
  .amdhsa_user_sgpr_count 2
  .amdhsa_user_sgpr_kernarg_segment_ptr 1
  .amdhsa_system_sgpr_workgroup_id_x 1
.end_amdhsa_kernel
```
